```python
import torch

def _softmax(x, axis=-1):
    return torch.softmax(x, dim=axis)
def _gelu(x):
    return torch.nn.functional.gelu(x, approximate="tanh")
def _silu(x):
    return torch.nn.functional.silu(x)
def _sigmoid(x):
    return torch.sigmoid(x)
def _layernorm(x, axis=-1, eps=1e-5):
    m = x.mean(dim=axis, keepdim=True)
    v = x.var(dim=axis, keepdim=True, unbiased=False)
    return (x - m) / torch.sqrt(v + eps)
def _scatter_add(tgt, idx, src, axis=0):
    return tgt.clone().index_add_(axis, idx, src)
def _segment_sum(src, seg, n):
    out = torch.zeros((n,) + src.shape[1:], dtype=src.dtype)
    return out.index_add_(0, seg, src)
def _pad(x, pw):
    flat = tuple(v for pair in reversed(pw) for v in pair)
    return torch.nn.functional.pad(x, flat)

kernel_name = 'interleave_layers__ssm_conv_s4d__linear_kernel_hedgehog__prompt'

def setup_inputs():

    _w = (lambda a: (lambda t: t.to(torch.bfloat16) if t.is_floating_point() else t)(torch.as_tensor(a)))
    def _A_setup():
        Bsz, L, D, N = 1, 2048, 512, 128
        return {
            "u": _w((lambda *s: torch.randn(*s, dtype=torch.bfloat16) * 0.05)(Bsz, L, D)),
            "log_A_real": _w((lambda *s: torch.randn(*s, dtype=torch.bfloat16) * 3.2)(D, N) * 0.5),
            "A_imag": _w((lambda *s: torch.randn(*s, dtype=torch.bfloat16) * 0.05)(D, N) * 3.14),
            "C_real": _w((lambda *s: torch.randn(*s, dtype=torch.bfloat16) * 0.05)(D, N) / N ** 0.5),
            "C_imag": _w((lambda *s: torch.randn(*s, dtype=torch.bfloat16) * 0.05)(D, N) / N ** 0.5),
            "log_dt": _w((lambda *s: torch.randn(*s, dtype=torch.bfloat16) * 0.05)(D) * 0.5 - 4.0),
            "D_skip": _w((lambda *s: torch.randn(*s, dtype=torch.bfloat16) * 0.05)(D)),
        }
    _A_in = _A_setup()

    def _B_setup():
        B, S, D, H = 1, 2048, 512, 32
        Dh = D // H
        return {
            "x": _w((lambda *s: torch.randn(*s, dtype=torch.bfloat16) * 0.05)(B, S, D)),
            "wqkv": _w((lambda *s: torch.randn(*s, dtype=torch.bfloat16) * 0.4)(D, 3 * D)),
            "w_phi": _w((lambda *s: torch.randn(*s, dtype=torch.bfloat16) * 0.4)(H, Dh, Dh) * (Dh ** -0.5)),
            "wo": _w((lambda *s: torch.randn(*s, dtype=torch.bfloat16) * 0.05)(D, D)),
        }
    _B_in = _B_setup()

    return {
        "A_u": _A_in["u"],
        "A_log_A_real": _A_in["log_A_real"],
        "A_A_imag": _A_in["A_imag"],
        "A_C_real": _A_in["C_real"],
        "A_C_imag": _A_in["C_imag"],
        "A_log_dt": _A_in["log_dt"],
        "A_D_skip": _A_in["D_skip"],
        "B_x": _B_in["x"],
        "B_wqkv": _B_in["wqkv"],
        "B_w_phi": _B_in["w_phi"],
        "B_wo": _B_in["wo"],
    }

def reference(A_u, A_log_A_real, A_A_imag, A_C_real, A_C_imag, A_log_dt, A_D_skip, B_x, B_wqkv, B_w_phi, B_wo):
    def _A_ref(u, log_A_real, A_imag, C_real, C_imag, log_dt, D_skip):
        L = u.shape[1]
        dt = torch.exp(log_dt)
        A = -torch.exp(log_A_real) + 1j * A_imag
        C = (C_real + 1j * C_imag) * dt[:, None]
        pos = (lambda x, dt: x.to(dt))(torch.arange(L), log_dt.dtype)
        P = torch.exp((A * dt[:, None])[:, :, None] * pos[None, None, :])
        K = 2.0 * torch.einsum("dn,dnl->dl", C, P).real
        L2 = 2 * L
        u_t = (lambda x, *d: x.permute(*d))(u, 0, 2, 1)
        Kf = (lambda x, *a, **k: torch.fft.rfft(x.float(), *a, **k))(K, L2)
        Uf = (lambda x, *a, **k: torch.fft.rfft(x.float(), *a, **k))(u_t, L2)
        y = (lambda x, *a, **k: torch.fft.irfft(x, *a, **k).to(torch.bfloat16))(Uf * Kf[None, :, :], L2)[:, :, :L]
        y = (lambda x, *d: x.permute(*d))(y, 0, 2, 1)
        return y + u * D_skip[None, None, :]

    def _B_ref(x, wqkv, w_phi, wo):
        B, S, D = x.shape
        H = 32; Dh = D // H
        qkv = (lambda x, *d: x.permute(*d))((x @ wqkv).reshape(B, S, 3, H, Dh), 2, 0, 3, 1, 4)
        q, k, v = qkv[0], qkv[1], qkv[2]
        pq = torch.einsum("bhsd,hdf->bhsf", q, w_phi)
        pk = torch.einsum("bhsd,hdf->bhsf", k, w_phi)
        phi_q = torch.concatenate([_softmax(pq, axis=-1), _softmax(-pq, axis=-1)], axis=-1)
        phi_k = torch.concatenate([_softmax(pk, axis=-1), _softmax(-pk, axis=-1)], axis=-1)
        kv = torch.einsum("bhsf,bhsd->bhfd", phi_k, v)
        z  = torch.einsum("bhsf->bhf", phi_k)
        num = torch.einsum("bhqf,bhfd->bhqd", phi_q, kv)
        den = torch.einsum("bhqf,bhf->bhq", phi_q, z)[..., None] + 1e-6
        o = num / den
        return (lambda x, *d: x.permute(*d))(o, 0, 2, 1, 3).reshape(B, S, D) @ wo

    x = A_u
    x = x + _A_ref(_layernorm(x, axis=-1), A_log_A_real, A_A_imag, A_C_real, A_C_imag, A_log_dt, A_D_skip)
    x = x + _B_ref(_layernorm(x, axis=-1), B_wqkv, B_w_phi, B_wo)
    x = x + _A_ref(_layernorm(x, axis=-1), A_log_A_real, A_A_imag, A_C_real, A_C_imag, A_log_dt, A_D_skip)
    x = x + _B_ref(_layernorm(x, axis=-1), B_wqkv, B_w_phi, B_wo)
    return x
```

```asm
; @launch kernel=interleave_layers__ssm_conv_s4d__linear_kernel_hedgehog__prompt_kernel grid=(256,1,1) block=(512,1,1) lds=163840
.amdgcn_target "amdgcn-amd-amdhsa--gfx950"
.text
.globl interleave_layers__ssm_conv_s4d__linear_kernel_hedgehog__prompt_kernel
.p2align 8
.type interleave_layers__ssm_conv_s4d__linear_kernel_hedgehog__prompt_kernel,@function
interleave_layers__ssm_conv_s4d__linear_kernel_hedgehog__prompt_kernel:
    s_cmp_ge_u32 s2, 256
    s_cbranch_scc1 mg_end
    s_load_dwordx16 s[64:79], s[0:1], 0
    s_load_dwordx8 s[80:87], s[0:1], 64
    s_load_dwordx4 s[88:91], s[0:1], 96
    s_getpc_b64 s[4:5]
mg_pc:
    v_lshlrev_b32 v9, 7, v0
    v_cmp_gt_u32 vcc, mg_end-mg_pc, v9
    s_and_saveexec_b64 s[6:7], vcc
    s_cbranch_execz mg_npf
    global_load_dword v239, v9, s[4:5]
mg_npf:
    s_mov_b64 exec, s[6:7]
    v_lshrrev_b32 v1, 6, v0
    v_and_b32 v2, 63, v0
    v_readfirstlane_b32 s47, v1
    v_lshlrev_b32 v3, 4, v2
    s_lshr_b32 s48, s47, 2
    s_and_b32 s49, s47, 3
    s_and_b32 s3, s2, 7
    s_lshl_b32 s3, s3, 5
    s_lshr_b32 s4, s2, 3
    s_add_u32 s57, s3, s4
    v_mov_b32 v4, 0
    v_mov_b32 v5, 0
    v_mov_b32 v6, 0
    v_mov_b32 v7, 0
    v_lshlrev_b32 v8, 4, v0
    v_lshrrev_b32 v9, 4, v0
    v_lshlrev_b32 v9, 10, v9
    v_and_b32 v10, 15, v0
    v_lshl_add_u32 v9, v10, 4, v9
    s_lshr_b32 s32, s2, 2
    s_lshl_b32 s32, s32, 15
    s_and_b32 s5, s2, 3
    s_lshl_b32 s5, s5, 8
    s_add_u32 s32, s32, s5
    s_lshl_b32 s5, s47, 10
    s_add_u32 m0, s5, 135680
    s_lshl_b32 s33, s2, 13
    s_lshl_b32 s34, s2, 3
    s_add_u32 s34, s34, s47
    s_mov_b32 s42, 2097152
    s_mov_b32 s43, 0x20000
    s_mov_b32 s30, 23068672
    s_mov_b32 s31, 0x20000
    s_waitcnt lgkmcnt(0)
    s_mov_b32 s40, s64
    s_mov_b32 s41, s65
    s_mov_b32 s28, s90
    s_mov_b32 s29, s91
    buffer_load_dwordx4 v[52:55], v8, s[40:43], s33 offen
    buffer_load_dwordx4 v9, s[40:43], s32 offen lds
    s_barrier
    s_mov_b32 s4, 19283968
    buffer_load_dword v60, v4, s[28:31], s4 offen sc1
    v_and_b32 v9, 255, v0
    v_lshlrev_b32 v9, 1, v9
    s_lshl_b32 s3, s57, 9
    s_mov_b32 s42, 131072
    s_mov_b32 s40, s66
    s_mov_b32 s41, s67
    buffer_load_ushort v10, v9, s[40:43], s3 offen
    s_mov_b32 s40, s68
    s_mov_b32 s41, s69
    buffer_load_ushort v11, v9, s[40:43], s3 offen
    s_mov_b32 s40, s74
    s_mov_b32 s41, s75
    s_mov_b32 s42, 1024
    s_lshl_b32 s35, s57, 2
    s_and_b32 s4, s47, 2
    s_add_u32 s4, s4, s35
    buffer_load_ushort v15, v4, s[40:43], s4 offen
    s_mov_b32 s42, 131072
    s_mov_b32 s40, s70
    s_mov_b32 s41, s71
    buffer_load_ushort v12, v9, s[40:43], s3 offen
    s_mov_b32 s40, s72
    s_mov_b32 s41, s73
    buffer_load_ushort v13, v9, s[40:43], s3 offen
    s_mov_b32 s36, s33
    s_mov_b32 s24, s86
    s_mov_b32 s25, s87
    s_mov_b32 s26, 2097152
    s_mov_b32 s27, 0x20000
    s_mov_b32 s50, 0
    s_mov_b32 s52, 0
    s_mov_b32 s53, 19267584
    s_mov_b32 s54, 22151168
    s_mov_b32 s63, 19922944
    s_mov_b32 s55, 8388608
    s_mov_b32 s56, 19353600
    s_mov_b32 s62, 18890752
    v_add_u32 v14, 133120, v8
    v_cmp_gt_u32 vcc, 160, v0
    s_and_saveexec_b64 s[6:7], vcc
    ds_write_b128 v14, v[4:7]
    ds_write_b128 v8, v[4:7] offset:9600
    ds_write_b128 v8, v[4:7] offset:21888
    s_mov_b64 exec, s[6:7]
    v_and_b32 v16, 7, v0
    v_mul_u32_u24 v16, 1312, v16
    v_lshrrev_b32 v17, 3, v0
    v_lshl_add_u32 v16, v17, 4, v16
    v_cmp_gt_u32 vcc, 144, v0
    s_and_saveexec_b64 s[6:7], vcc
    ds_write_b128 v16, v[4:7] offset:24576
    s_mov_b64 exec, s[6:7]
    s_cmp_lg_u32 s47, 6
    s_cbranch_scc1 mg_zw1
    s_mov_b64 exec, 0xf
    ds_write_b128 v3, v[4:7] offset:35200
    ds_write_b128 v3, v[4:7] offset:38400
    ds_write_b128 v3, v[4:7] offset:41600
    ds_write_b128 v3, v[4:7] offset:43776
    ds_write_b128 v3, v[4:7] offset:45952
    ds_write_b128 v3, v[4:7] offset:48128
    ds_write_b128 v3, v[4:7] offset:51328
    ds_write_b128 v3, v[4:7] offset:54528
    ds_write_b128 v3, v[4:7] offset:56704
    ds_write_b128 v3, v[4:7] offset:58880
    s_mov_b64 exec, -1
mg_zw1:
    v_lshrrev_b32 v62, 4, v2
    v_bfe_u32 v63, v0, 2, 2
    v_lshl_add_u32 v63, v62, 3, v63
    v_lshlrev_b32 v63, 8, v63
    v_and_b32 v58, 3, v0
    v_lshl_add_u32 v63, v58, 3, v63
    s_lshl_b32 s4, s47, 5
    s_add_u32 s4, s4, 135680
    v_add_u32 v63, s4, v63
    v_and_b32 v61, 15, v0
    v_lshlrev_b32 v61, 6, v61
    v_lshl_add_u32 v61, v62, 4, v61
    v_mov_b32 v56, 0
    v_mov_b32 v57, 0
    v_mov_b32 v58, 0x3f803f80
    s_waitcnt vmcnt(6)
    s_barrier
    ds_read_b64_tr_b16 v[48:49], v63
    ds_read_b64_tr_b16 v[50:51], v63 offset:1024
    v_dot2c_f32_bf16 v56, v52, v58
    v_dot2c_f32_bf16 v57, v52, v52
    v_dot2c_f32_bf16 v56, v53, v58
    v_dot2c_f32_bf16 v57, v53, v53
    v_dot2c_f32_bf16 v56, v54, v58
    v_dot2c_f32_bf16 v57, v54, v54
    v_dot2c_f32_bf16 v56, v55, v58
    v_dot2c_f32_bf16 v57, v55, v55
    s_lshl_b32 s5, s47, 10
    s_add_u32 s4, s36, s5
    s_add_u32 s4, s4, 0
    s_waitcnt lgkmcnt(0)
    buffer_store_dwordx4 v[48:51], v61, s[28:31], s4 offen sc1
    v_permlane32_swap_b32 v56, v57
    v_add_f32 v56, v56, v57
    s_nop 1
    v_add_f32_dpp v56, v56, v56 row_ror:8 row_mask:0xf bank_mask:0xf
    s_nop 1
    v_add_f32_dpp v56, v56, v56 row_ror:4 row_mask:0xf bank_mask:0xf
    s_nop 1
    v_add_f32_dpp v56, v56, v56 row_ror:2 row_mask:0xf bank_mask:0xf
    s_nop 1
    v_add_f32_dpp v56, v56, v56 row_ror:1 row_mask:0xf bank_mask:0xf
    v_mov_b32 v57, v56
    s_nop 1
    v_permlane16_swap_b32 v56, v57
    v_add_f32 v56, v56, v57
    s_lshl_b32 s4, s47, 3
    s_add_u32 s4, s4, 163776
    v_lshrrev_b32 v58, 3, v2
    v_add_u32 v58, s4, v58
    s_mov_b32 exec_lo, 1
    s_mov_b32 exec_hi, 1
    ds_write_b32 v58, v56
    s_mov_b64 exec, -1
    s_waitcnt vmcnt(1) lgkmcnt(0)
    s_barrier
    s_cmp_lg_u32 s47, 0
    s_cbranch_scc1 mg_ns2
    v_add_u32 v58, 163776, v3
    s_mov_b64 exec, 0xf
    ds_read_b128 v[52:55], v58
    s_lshl_b32 s4, s2, 6
    s_add_u32 s4, s4, 19267584
    s_waitcnt lgkmcnt(0)
    buffer_store_dwordx4 v[52:55], v3, s[28:31], s4 offen sc1
    s_mov_b64 exec, 0xffff
    s_lshl_b32 s4, s2, 8
    s_add_u32 s4, s4, 19353600
    buffer_store_dwordx4 v[4:7], v3, s[28:31], s4 offen sc1
mg_ns2:
    s_mov_b64 exec, -1
    s_cmp_lt_u32 s47, 4
    s_cbranch_scc1 mg_nwl3
    s_bfe_u32 s58, s2, 0x20002
    s_lshr_b32 s32, s2, 4
    s_and_b32 s33, s2, 3
    s_mov_b32 s40, s80
    s_mov_b32 s41, s81
    s_mov_b32 s42, 0x180000
    s_movk_i32 s35, 3072
    s_lshl_b32 s34, s58, 10
    s_cmp_lg_u32 s58, 3
    s_cbranch_scc1 mg_nwo4
    s_mov_b32 s40, s84
    s_mov_b32 s41, s85
    s_mov_b32 s42, 0x80000
    s_movk_i32 s35, 1024
    s_mov_b32 s34, 0
mg_nwo4:
    v_bfe_u32 v18, v0, 4, 4
    v_mul_lo_u32 v18, v18, s35
    v_and_b32 v19, 15, v0
    v_lshl_add_u32 v18, v19, 4, v18
    s_mul_i32 s4, s35, s32
    s_lshl_b32 s4, s4, 5
    s_add_u32 s34, s34, s4
    s_lshl_b32 s4, s33, 8
    s_add_u32 s34, s34, s4
    s_lshl_b32 s5, s49, 10
    s_add_u32 m0, s5, 143872
    s_nop 0
    buffer_load_dwordx4 v18, s[40:43], s34 offen lds
    s_lshl_b32 s4, s35, 4
    s_add_u32 s34, s34, s4
    s_add_u32 m0, s5, 147968
    s_nop 0
    buffer_load_dwordx4 v18, s[40:43], s34 offen lds
    s_mov_b32 s40, s82
    s_mov_b32 s41, s83
    s_mov_b32 s42, 16384
    s_lshl_b32 s33, s33, 2
    s_add_u32 s33, s33, s49
    s_lshl_b32 s4, s33, 10
    s_lshl_b32 s5, s49, 10
    s_add_u32 m0, s5, 152064
    s_nop 0
    buffer_load_dwordx4 v3, s[40:43], s4 offen lds
    s_mul_i32 s59, s33, 98304
    s_lshl_b32 s4, s58, 10
    s_add_u32 s59, s59, s4
    s_add_u32 s59, s59, 16777216
    s_lshl_b32 s4, s33, 15
    s_add_u32 s4, s4, 18350080
    s_cmp_eq_u32 s58, 3
    s_cselect_b32 s59, s4, s59
    s_mul_i32 s4, s35, s32
    s_lshl_b32 s4, s4, 1
    s_add_u32 s59, s59, s4
    s_add_u32 s60, s59, s35
    s_lshl_b32 s61, s58, 11
    s_lshl_b32 s4, s33, 7
    s_add_u32 s61, s61, s4
    s_add_u32 s61, s61, 19402752
mg_nwl3:
    v_and_b32 v16, 127, v0
    v_lshlrev_b32 v16, 2, v16
    v_bfe_u32 v17, v0, 7, 1
    v_mul_u32_u24 v17, 16896, v17
    v_add_u32 v16, v16, v17
    v_add_u32 v16, 65536, v16
    v_mov_b32 v14, 1069066811
    v_lshlrev_b32 v10, 16, v10
    v_mul_f32 v10, v10, v14
    v_exp_f32 v10, v10
    v_lshlrev_b32 v15, 16, v15
    v_mul_f32 v15, v15, v14
    v_exp_f32 v15, v15
    v_lshlrev_b32 v11, 16, v11
    v_cvt_pk_bf16_f32 v15, v15, v10
    v_and_b32 v10, 0xffff0000, v15
    v_lshlrev_b32 v15, 16, v15
    v_mul_f32 v10, v10, v15
    v_mul_f32 v11, v11, v15
    v_mul_f32 v10, 0xbfb8aa3b, v10
    v_mul_f32 v11, 0.15915494, v11
    v_readfirstlane_b32 s94, v60
    s_getreg_b32 s92, hwreg(HW_REG_XCC_ID)
    s_add_u32 s94, s94, 1
    s_cmp_ge_u32 s47, 4
    s_cbranch_scc1 mg_role15
    v_mul_f32 v18, 0x41000000, v10
    v_mul_f32 v19, 0x41000000, v11
    v_exp_f32 v18, v18
    v_fract_f32 v19, v19
    v_cos_f32 v20, v19
    v_sin_f32 v21, v19
    v_mul_f32 v20, v20, v18
    v_mul_f32 v21, v21, v18
    v_sub_f32 v22, 0, v21
    v_mov_b32 v23, v20
    v_mov_b32 v28, 0x3f80
    ds_write_b32 v16, v28 offset:33792
    v_cvt_pk_bf16_f32 v29, v20, v21
    ds_write_b32 v16, v29 offset:34320
    v_pk_mul_f32 v[18:19], v[20:21], v[20:21] op_sel:[0,0] op_sel_hi:[0,1]
    v_pk_fma_f32 v[24:25], v[20:21], v[22:23], v[18:19] op_sel:[1,0,0] op_sel_hi:[1,1,1]
    v_cvt_pk_bf16_f32 v28, v24, v25
    ds_write_b32 v16, v28 offset:34848
    v_pk_mul_f32 v[18:19], v[24:25], v[20:21] op_sel:[0,0] op_sel_hi:[0,1]
    v_pk_fma_f32 v[26:27], v[24:25], v[22:23], v[18:19] op_sel:[1,0,0] op_sel_hi:[1,1,1]
    v_cvt_pk_bf16_f32 v29, v26, v27
    ds_write_b32 v16, v29 offset:35376
    v_pk_mul_f32 v[18:19], v[26:27], v[20:21] op_sel:[0,0] op_sel_hi:[0,1]
    v_pk_fma_f32 v[24:25], v[26:27], v[22:23], v[18:19] op_sel:[1,0,0] op_sel_hi:[1,1,1]
    v_cvt_pk_bf16_f32 v28, v24, v25
    ds_write_b32 v16, v28 offset:35904
    v_pk_mul_f32 v[18:19], v[24:25], v[20:21] op_sel:[0,0] op_sel_hi:[0,1]
    v_pk_fma_f32 v[26:27], v[24:25], v[22:23], v[18:19] op_sel:[1,0,0] op_sel_hi:[1,1,1]
    v_cvt_pk_bf16_f32 v29, v26, v27
    ds_write_b32 v16, v29 offset:36432
    v_pk_mul_f32 v[18:19], v[26:27], v[20:21] op_sel:[0,0] op_sel_hi:[0,1]
    v_pk_fma_f32 v[24:25], v[26:27], v[22:23], v[18:19] op_sel:[1,0,0] op_sel_hi:[1,1,1]
    v_cvt_pk_bf16_f32 v28, v24, v25
    ds_write_b32 v16, v28 offset:36960
    v_pk_mul_f32 v[18:19], v[24:25], v[20:21] op_sel:[0,0] op_sel_hi:[0,1]
    v_pk_fma_f32 v[26:27], v[24:25], v[22:23], v[18:19] op_sel:[1,0,0] op_sel_hi:[1,1,1]
    v_cvt_pk_bf16_f32 v29, v26, v27
    ds_write_b32 v16, v29 offset:37488
    v_pk_mul_f32 v[18:19], v[26:27], v[20:21] op_sel:[0,0] op_sel_hi:[0,1]
    v_pk_fma_f32 v[24:25], v[26:27], v[22:23], v[18:19] op_sel:[1,0,0] op_sel_hi:[1,1,1]
    v_cvt_pk_bf16_f32 v28, v24, v25
    ds_write_b32 v16, v28 offset:38016
    v_pk_mul_f32 v[18:19], v[24:25], v[20:21] op_sel:[0,0] op_sel_hi:[0,1]
    v_pk_fma_f32 v[26:27], v[24:25], v[22:23], v[18:19] op_sel:[1,0,0] op_sel_hi:[1,1,1]
    v_cvt_pk_bf16_f32 v29, v26, v27
    ds_write_b32 v16, v29 offset:38544
    v_pk_mul_f32 v[18:19], v[26:27], v[20:21] op_sel:[0,0] op_sel_hi:[0,1]
    v_pk_fma_f32 v[24:25], v[26:27], v[22:23], v[18:19] op_sel:[1,0,0] op_sel_hi:[1,1,1]
    v_cvt_pk_bf16_f32 v28, v24, v25
    ds_write_b32 v16, v28 offset:39072
    v_pk_mul_f32 v[18:19], v[24:25], v[20:21] op_sel:[0,0] op_sel_hi:[0,1]
    v_pk_fma_f32 v[26:27], v[24:25], v[22:23], v[18:19] op_sel:[1,0,0] op_sel_hi:[1,1,1]
    v_cvt_pk_bf16_f32 v29, v26, v27
    ds_write_b32 v16, v29 offset:39600
    v_pk_mul_f32 v[18:19], v[26:27], v[20:21] op_sel:[0,0] op_sel_hi:[0,1]
    v_pk_fma_f32 v[24:25], v[26:27], v[22:23], v[18:19] op_sel:[1,0,0] op_sel_hi:[1,1,1]
    v_cvt_pk_bf16_f32 v28, v24, v25
    ds_write_b32 v16, v28 offset:40128
    v_pk_mul_f32 v[18:19], v[24:25], v[20:21] op_sel:[0,0] op_sel_hi:[0,1]
    v_pk_fma_f32 v[26:27], v[24:25], v[22:23], v[18:19] op_sel:[1,0,0] op_sel_hi:[1,1,1]
    v_cvt_pk_bf16_f32 v29, v26, v27
    ds_write_b32 v16, v29 offset:40656
    v_pk_mul_f32 v[18:19], v[26:27], v[20:21] op_sel:[0,0] op_sel_hi:[0,1]
    v_pk_fma_f32 v[24:25], v[26:27], v[22:23], v[18:19] op_sel:[1,0,0] op_sel_hi:[1,1,1]
    v_cvt_pk_bf16_f32 v28, v24, v25
    ds_write_b32 v16, v28 offset:41184
    v_pk_mul_f32 v[18:19], v[24:25], v[20:21] op_sel:[0,0] op_sel_hi:[0,1]
    v_pk_fma_f32 v[26:27], v[24:25], v[22:23], v[18:19] op_sel:[1,0,0] op_sel_hi:[1,1,1]
    v_cvt_pk_bf16_f32 v29, v26, v27
    ds_write_b32 v16, v29 offset:41712
    s_waitcnt vmcnt(0)
    s_barrier
    s_cmp_lg_u32 s47, 0
    s_cbranch_scc1 mg_tp7
    s_lshl_b32 s4, s57, 7
    s_add_u32 s4, s4, 19288064
    v_mov_b32 v4, s94
    v_mov_b32 v5, s92
    v_mov_b32 v6, s94
    v_mov_b32 v7, s92
    s_mov_b64 exec, 0xff
    buffer_store_dwordx4 v[4:7], v3, s[28:31], s4 offen sc1
    s_mov_b64 exec, -1
mg_tp7:
    v_pk_mul_f32 v[18:19], v[26:27], v[20:21] op_sel:[0,0] op_sel_hi:[0,1]
    v_pk_fma_f32 v[24:25], v[26:27], v[22:23], v[18:19] op_sel:[1,0,0] op_sel_hi:[1,1,1]
    v_cvt_pk_bf16_f32 v28, v24, v25
    ds_write_b32 v16, v28 offset:42240
    v_pk_mul_f32 v[18:19], v[24:25], v[20:21] op_sel:[0,0] op_sel_hi:[0,1]
    v_pk_fma_f32 v[26:27], v[24:25], v[22:23], v[18:19] op_sel:[1,0,0] op_sel_hi:[1,1,1]
    v_cvt_pk_bf16_f32 v29, v26, v27
    ds_write_b32 v16, v29 offset:42768
    v_pk_mul_f32 v[18:19], v[26:27], v[20:21] op_sel:[0,0] op_sel_hi:[0,1]
    v_pk_fma_f32 v[24:25], v[26:27], v[22:23], v[18:19] op_sel:[1,0,0] op_sel_hi:[1,1,1]
    v_cvt_pk_bf16_f32 v28, v24, v25
    ds_write_b32 v16, v28 offset:43296
    v_pk_mul_f32 v[18:19], v[24:25], v[20:21] op_sel:[0,0] op_sel_hi:[0,1]
    v_pk_fma_f32 v[26:27], v[24:25], v[22:23], v[18:19] op_sel:[1,0,0] op_sel_hi:[1,1,1]
    v_cvt_pk_bf16_f32 v29, v26, v27
    ds_write_b32 v16, v29 offset:43824
    v_pk_mul_f32 v[18:19], v[26:27], v[20:21] op_sel:[0,0] op_sel_hi:[0,1]
    v_pk_fma_f32 v[24:25], v[26:27], v[22:23], v[18:19] op_sel:[1,0,0] op_sel_hi:[1,1,1]
    v_cvt_pk_bf16_f32 v28, v24, v25
    ds_write_b32 v16, v28 offset:44352
    v_pk_mul_f32 v[18:19], v[24:25], v[20:21] op_sel:[0,0] op_sel_hi:[0,1]
    v_pk_fma_f32 v[26:27], v[24:25], v[22:23], v[18:19] op_sel:[1,0,0] op_sel_hi:[1,1,1]
    v_cvt_pk_bf16_f32 v29, v26, v27
    ds_write_b32 v16, v29 offset:44880
    v_pk_mul_f32 v[18:19], v[26:27], v[20:21] op_sel:[0,0] op_sel_hi:[0,1]
    v_pk_fma_f32 v[24:25], v[26:27], v[22:23], v[18:19] op_sel:[1,0,0] op_sel_hi:[1,1,1]
    v_cvt_pk_bf16_f32 v28, v24, v25
    ds_write_b32 v16, v28 offset:45408
    v_pk_mul_f32 v[18:19], v[24:25], v[20:21] op_sel:[0,0] op_sel_hi:[0,1]
    v_pk_fma_f32 v[26:27], v[24:25], v[22:23], v[18:19] op_sel:[1,0,0] op_sel_hi:[1,1,1]
    v_cvt_pk_bf16_f32 v29, v26, v27
    ds_write_b32 v16, v29 offset:45936
    v_pk_mul_f32 v[18:19], v[26:27], v[20:21] op_sel:[0,0] op_sel_hi:[0,1]
    v_pk_fma_f32 v[24:25], v[26:27], v[22:23], v[18:19] op_sel:[1,0,0] op_sel_hi:[1,1,1]
    v_cvt_pk_bf16_f32 v28, v24, v25
    ds_write_b32 v16, v28 offset:46464
    v_pk_mul_f32 v[18:19], v[24:25], v[20:21] op_sel:[0,0] op_sel_hi:[0,1]
    v_pk_fma_f32 v[26:27], v[24:25], v[22:23], v[18:19] op_sel:[1,0,0] op_sel_hi:[1,1,1]
    v_cvt_pk_bf16_f32 v29, v26, v27
    ds_write_b32 v16, v29 offset:46992
    v_pk_mul_f32 v[18:19], v[26:27], v[20:21] op_sel:[0,0] op_sel_hi:[0,1]
    v_pk_fma_f32 v[24:25], v[26:27], v[22:23], v[18:19] op_sel:[1,0,0] op_sel_hi:[1,1,1]
    v_cvt_pk_bf16_f32 v28, v24, v25
    ds_write_b32 v16, v28 offset:47520
    v_pk_mul_f32 v[18:19], v[24:25], v[20:21] op_sel:[0,0] op_sel_hi:[0,1]
    v_pk_fma_f32 v[26:27], v[24:25], v[22:23], v[18:19] op_sel:[1,0,0] op_sel_hi:[1,1,1]
    v_cvt_pk_bf16_f32 v29, v26, v27
    ds_write_b32 v16, v29 offset:48048
    v_pk_mul_f32 v[18:19], v[26:27], v[20:21] op_sel:[0,0] op_sel_hi:[0,1]
    v_pk_fma_f32 v[24:25], v[26:27], v[22:23], v[18:19] op_sel:[1,0,0] op_sel_hi:[1,1,1]
    v_cvt_pk_bf16_f32 v28, v24, v25
    ds_write_b32 v16, v28 offset:48576
    v_pk_mul_f32 v[18:19], v[24:25], v[20:21] op_sel:[0,0] op_sel_hi:[0,1]
    v_pk_fma_f32 v[26:27], v[24:25], v[22:23], v[18:19] op_sel:[1,0,0] op_sel_hi:[1,1,1]
    v_cvt_pk_bf16_f32 v29, v26, v27
    ds_write_b32 v16, v29 offset:49104
    v_pk_mul_f32 v[18:19], v[26:27], v[20:21] op_sel:[0,0] op_sel_hi:[0,1]
    v_pk_fma_f32 v[24:25], v[26:27], v[22:23], v[18:19] op_sel:[1,0,0] op_sel_hi:[1,1,1]
    v_cvt_pk_bf16_f32 v28, v24, v25
    ds_write_b32 v16, v28 offset:49632
    v_pk_mul_f32 v[18:19], v[24:25], v[20:21] op_sel:[0,0] op_sel_hi:[0,1]
    v_pk_fma_f32 v[26:27], v[24:25], v[22:23], v[18:19] op_sel:[1,0,0] op_sel_hi:[1,1,1]
    v_cvt_pk_bf16_f32 v29, v26, v27
    ds_write_b32 v16, v29 offset:50160
    s_branch mg_tabdone6
mg_role15:
    v_exp_f32 v18, v10
    v_fract_f32 v19, v11
    v_cos_f32 v20, v19
    v_sin_f32 v21, v19
    v_mul_f32 v20, v20, v18
    v_mul_f32 v21, v21, v18
    v_sub_f32 v22, 0, v21
    v_mov_b32 v23, v20
    v_mul_f32 v18, 0x43800000, v10
    v_mul_f32 v19, 0x43800000, v11
    v_exp_f32 v18, v18
    v_fract_f32 v19, v19
    v_cos_f32 v24, v19
    v_sin_f32 v25, v19
    v_mul_f32 v24, v24, v18
    v_mul_f32 v25, v25, v18
    v_sub_f32 v26, 0, v25
    v_mov_b32 v27, v24
    v_add_f32 v15, v15, v15
    v_lshlrev_b32 v12, 16, v12
    v_lshlrev_b32 v13, 16, v13
    v_mul_f32 v30, v12, v15
    v_mul_f32 v31, v13, v15
    v_cvt_pk_bf16_f32 v28, v30, -v31
    ds_write_b32 v16, v28 offset:0
    v_pk_mul_f32 v[18:19], v[30:31], v[20:21] op_sel:[0,0] op_sel_hi:[0,1]
    v_pk_fma_f32 v[32:33], v[30:31], v[22:23], v[18:19] op_sel:[1,0,0] op_sel_hi:[1,1,1]
    v_cvt_pk_bf16_f32 v29, v32, -v33
    ds_write_b32 v16, v29 offset:528
    v_pk_mul_f32 v[18:19], v[32:33], v[20:21] op_sel:[0,0] op_sel_hi:[0,1]
    v_pk_fma_f32 v[34:35], v[32:33], v[22:23], v[18:19] op_sel:[1,0,0] op_sel_hi:[1,1,1]
    v_cvt_pk_bf16_f32 v28, v34, -v35
    ds_write_b32 v16, v28 offset:1056
    v_pk_mul_f32 v[18:19], v[34:35], v[20:21] op_sel:[0,0] op_sel_hi:[0,1]
    v_pk_fma_f32 v[36:37], v[34:35], v[22:23], v[18:19] op_sel:[1,0,0] op_sel_hi:[1,1,1]
    v_cvt_pk_bf16_f32 v29, v36, -v37
    ds_write_b32 v16, v29 offset:1584
    v_pk_mul_f32 v[18:19], v[36:37], v[20:21] op_sel:[0,0] op_sel_hi:[0,1]
    v_pk_fma_f32 v[38:39], v[36:37], v[22:23], v[18:19] op_sel:[1,0,0] op_sel_hi:[1,1,1]
    v_cvt_pk_bf16_f32 v28, v38, -v39
    ds_write_b32 v16, v28 offset:2112
    v_pk_mul_f32 v[18:19], v[38:39], v[20:21] op_sel:[0,0] op_sel_hi:[0,1]
    v_pk_fma_f32 v[40:41], v[38:39], v[22:23], v[18:19] op_sel:[1,0,0] op_sel_hi:[1,1,1]
    v_cvt_pk_bf16_f32 v29, v40, -v41
    ds_write_b32 v16, v29 offset:2640
    v_pk_mul_f32 v[18:19], v[40:41], v[20:21] op_sel:[0,0] op_sel_hi:[0,1]
    v_pk_fma_f32 v[42:43], v[40:41], v[22:23], v[18:19] op_sel:[1,0,0] op_sel_hi:[1,1,1]
    v_cvt_pk_bf16_f32 v28, v42, -v43
    ds_write_b32 v16, v28 offset:3168
    v_pk_mul_f32 v[18:19], v[42:43], v[20:21] op_sel:[0,0] op_sel_hi:[0,1]
    v_pk_fma_f32 v[44:45], v[42:43], v[22:23], v[18:19] op_sel:[1,0,0] op_sel_hi:[1,1,1]
    v_cvt_pk_bf16_f32 v29, v44, -v45
    ds_write_b32 v16, v29 offset:3696
    v_pk_mul_f32 v[18:19], v[44:45], v[20:21] op_sel:[0,0] op_sel_hi:[0,1]
    v_pk_fma_f32 v[46:47], v[44:45], v[22:23], v[18:19] op_sel:[1,0,0] op_sel_hi:[1,1,1]
    s_waitcnt vmcnt(3)
    s_barrier
    v_pk_mul_f32 v[18:19], v[30:31], v[24:25] op_sel:[0,0] op_sel_hi:[0,1]
    v_pk_fma_f32 v[30:31], v[30:31], v[26:27], v[18:19] op_sel:[1,0,0] op_sel_hi:[1,1,1]
    v_cvt_pk_bf16_f32 v28, v30, -v31
    ds_write_b32 v16, v28 offset:4224
    v_pk_mul_f32 v[18:19], v[34:35], v[24:25] op_sel:[0,0] op_sel_hi:[0,1]
    v_pk_fma_f32 v[34:35], v[34:35], v[26:27], v[18:19] op_sel:[1,0,0] op_sel_hi:[1,1,1]
    v_cvt_pk_bf16_f32 v29, v34, -v35
    ds_write_b32 v16, v29 offset:4752
    v_pk_mul_f32 v[18:19], v[38:39], v[24:25] op_sel:[0,0] op_sel_hi:[0,1]
    v_pk_fma_f32 v[38:39], v[38:39], v[26:27], v[18:19] op_sel:[1,0,0] op_sel_hi:[1,1,1]
    v_cvt_pk_bf16_f32 v28, v38, -v39
    ds_write_b32 v16, v28 offset:5280
    ds_write_b32 v16, v28 offset:6336
    v_pk_mul_f32 v[18:19], v[42:43], v[24:25] op_sel:[0,0] op_sel_hi:[0,1]
    v_pk_fma_f32 v[42:43], v[42:43], v[26:27], v[18:19] op_sel:[1,0,0] op_sel_hi:[1,1,1]
    v_cvt_pk_bf16_f32 v29, v42, -v43
    ds_write_b32 v16, v29 offset:6864
    v_pk_mul_f32 v[18:19], v[46:47], v[24:25] op_sel:[0,0] op_sel_hi:[0,1]
    v_pk_fma_f32 v[46:47], v[46:47], v[26:27], v[18:19] op_sel:[1,0,0] op_sel_hi:[1,1,1]
    v_cvt_pk_bf16_f32 v28, v46, -v47
    ds_write_b32 v16, v28 offset:7392
    v_pk_mul_f32 v[18:19], v[38:39], v[24:25] op_sel:[0,0] op_sel_hi:[0,1]
    v_pk_fma_f32 v[38:39], v[38:39], v[26:27], v[18:19] op_sel:[1,0,0] op_sel_hi:[1,1,1]
    v_cvt_pk_bf16_f32 v29, v38, -v39
    ds_write_b32 v16, v29 offset:8448
    v_pk_mul_f32 v[18:19], v[46:47], v[24:25] op_sel:[0,0] op_sel_hi:[0,1]
    v_pk_fma_f32 v[46:47], v[46:47], v[26:27], v[18:19] op_sel:[1,0,0] op_sel_hi:[1,1,1]
    v_cvt_pk_bf16_f32 v28, v46, -v47
    ds_write_b32 v16, v28 offset:8976
    v_pk_mul_f32 v[18:19], v[38:39], v[24:25] op_sel:[0,0] op_sel_hi:[0,1]
    v_pk_fma_f32 v[38:39], v[38:39], v[26:27], v[18:19] op_sel:[1,0,0] op_sel_hi:[1,1,1]
    v_cvt_pk_bf16_f32 v29, v38, -v39
    ds_write_b32 v16, v29 offset:10560
    v_pk_mul_f32 v[18:19], v[46:47], v[24:25] op_sel:[0,0] op_sel_hi:[0,1]
    v_pk_fma_f32 v[46:47], v[46:47], v[26:27], v[18:19] op_sel:[1,0,0] op_sel_hi:[1,1,1]
    v_cvt_pk_bf16_f32 v28, v46, -v47
    ds_write_b32 v16, v28 offset:11088
    v_pk_mul_f32 v[18:19], v[46:47], v[24:25] op_sel:[0,0] op_sel_hi:[0,1]
    v_pk_fma_f32 v[46:47], v[46:47], v[26:27], v[18:19] op_sel:[1,0,0] op_sel_hi:[1,1,1]
    v_cvt_pk_bf16_f32 v29, v46, -v47
    ds_write_b32 v16, v29 offset:9504
    v_pk_mul_f32 v[18:19], v[46:47], v[24:25] op_sel:[0,0] op_sel_hi:[0,1]
    v_pk_fma_f32 v[46:47], v[46:47], v[26:27], v[18:19] op_sel:[1,0,0] op_sel_hi:[1,1,1]
    v_cvt_pk_bf16_f32 v28, v46, -v47
    ds_write_b32 v16, v28 offset:10032
    v_pk_mul_f32 v[18:19], v[46:47], v[24:25] op_sel:[0,0] op_sel_hi:[0,1]
    v_pk_fma_f32 v[46:47], v[46:47], v[26:27], v[18:19] op_sel:[1,0,0] op_sel_hi:[1,1,1]
    v_cvt_pk_bf16_f32 v29, v46, -v47
    ds_write_b32 v16, v29 offset:11616
    v_pk_mul_f32 v[18:19], v[46:47], v[24:25] op_sel:[0,0] op_sel_hi:[0,1]
    v_pk_fma_f32 v[46:47], v[46:47], v[26:27], v[18:19] op_sel:[1,0,0] op_sel_hi:[1,1,1]
    v_cvt_pk_bf16_f32 v28, v46, -v47
    ds_write_b32 v16, v28 offset:12144
mg_tabdone6:
    s_cmp_lt_u32 s47, 4
    s_cbranch_scc1 mg_nw08
    s_waitcnt vmcnt(0)
mg_nw08:
    s_waitcnt lgkmcnt(0)
    s_barrier
    s_mov_b32 s40, s76
    s_mov_b32 s41, s77
    s_mov_b32 s42, 1024
    s_lshl_b32 s4, s57, 2
    v_mov_b32 v9, 0
    buffer_load_dword v238, v9, s[40:43], s4 offen
    s_lshr_b32 s4, s47, 1
    s_cmp_lg_u32 s4, 1
    s_cbranch_scc1 mg_tw9
    s_and_b32 s4, s47, 1
    s_lshl_b32 s4, s4, 14
    s_add_u32 s4, s4, 19288064
    s_add_u32 s6, s4, 8192
    v_lshlrev_b32 v5, 7, v2
    s_mov_b32 s5, 0x40000
mg_tl10:
    s_sleep 4
    buffer_load_dword v4, v5, s[28:31], s4 offen sc1
    buffer_load_dword v6, v5, s[28:31], s6 offen sc1
    s_sub_u32 s5, s5, 1
    s_cbranch_scc1 mg_tw9
    s_waitcnt vmcnt(1)
    v_xor_b32 v4, s94, v4
    s_waitcnt vmcnt(0)
    v_xor_b32 v6, s94, v6
    v_or_b32 v4, v4, v6
    v_cmp_ne_u32 vcc, 0, v4
    s_cbranch_vccnz mg_tl10
mg_tw9:
    s_cmp_ge_u32 s47, 2
    s_cbranch_scc1 mg_nm11
    v_and_b32 v16, 31, v0
    v_bfe_u32 v17, v0, 5, 1
    v_mul_u32_u24 v18, 528, v16
    v_lshl_add_u32 v18, v17, 4, v18
    s_mul_i32 s4, s47, 16896
    s_add_u32 s4, s4, 65536
    v_add_u32 v18, s4, v18
    ds_read_b128 v[40:43], v18 offset:0
    ds_read_b128 v[44:47], v18 offset:33792
    ds_read_b128 v[48:51], v18 offset:32
    ds_read_b128 v[52:55], v18 offset:33824
    ds_read_b128 v[56:59], v18 offset:64
    ds_read_b128 v[60:63], v18 offset:33856
    ds_read_b128 v[64:67], v18 offset:96
    ds_read_b128 v[68:71], v18 offset:33888
    ds_read_b128 v[72:75], v18 offset:128
    ds_read_b128 v[76:79], v18 offset:33920
    ds_read_b128 v[80:83], v18 offset:160
    ds_read_b128 v[84:87], v18 offset:33952
    v_lshlrev_b32 v19, 3, v16
    v_lshl_add_u32 v19, v17, 2, v19
    s_mul_i32 s4, s47, 1280
    s_add_u32 s4, s4, 133752
    v_lshlrev_b32 v36, 1, v19
    v_sub_u32 v36, s4, v36
    s_mul_i32 s5, s47, 12288
    s_add_u32 s5, s5, 9600
    v_cmp_eq_u32 vcc, 63, v2
    v_lshlrev_b32 v37, 2, v2
    v_sub_u32 v37, s5, v37
    v_lshl_add_u32 v19, v17, 6, v16
    v_lshlrev_b32 v19, 1, v19
    v_sub_u32 v19, s5, v19
    s_waitcnt lgkmcnt(10)
    v_mfma_f32_32x32x16_bf16 v[20:35], v[40:43], v[44:47], 0
    ds_read_b128 v[40:43], v18 offset:192
    ds_read_b128 v[44:47], v18 offset:33984
    s_waitcnt lgkmcnt(10)
    v_mfma_f32_32x32x16_bf16 v[20:35], v[48:51], v[52:55], v[20:35]
    ds_read_b128 v[48:51], v18 offset:224
    ds_read_b128 v[52:55], v18 offset:34016
    s_waitcnt lgkmcnt(10)
    v_mfma_f32_32x32x16_bf16 v[20:35], v[56:59], v[60:63], v[20:35]
    ds_read_b128 v[56:59], v18 offset:256
    ds_read_b128 v[60:63], v18 offset:34048
    s_waitcnt lgkmcnt(10)
    v_mfma_f32_32x32x16_bf16 v[20:35], v[64:67], v[68:71], v[20:35]
    ds_read_b128 v[64:67], v18 offset:288
    ds_read_b128 v[68:71], v18 offset:34080
    s_waitcnt lgkmcnt(10)
    v_mfma_f32_32x32x16_bf16 v[20:35], v[72:75], v[76:79], v[20:35]
    ds_read_b128 v[72:75], v18 offset:320
    ds_read_b128 v[76:79], v18 offset:34112
    s_waitcnt lgkmcnt(10)
    v_mfma_f32_32x32x16_bf16 v[20:35], v[80:83], v[84:87], v[20:35]
    ds_read_b128 v[80:83], v18 offset:352
    ds_read_b128 v[84:87], v18 offset:34144
    s_waitcnt lgkmcnt(10)
    v_mfma_f32_32x32x16_bf16 v[20:35], v[40:43], v[44:47], v[20:35]
    ds_read_b128 v[40:43], v18 offset:384
    ds_read_b128 v[44:47], v18 offset:34176
    s_waitcnt lgkmcnt(10)
    v_mfma_f32_32x32x16_bf16 v[20:35], v[48:51], v[52:55], v[20:35]
    ds_read_b128 v[48:51], v18 offset:416
    ds_read_b128 v[52:55], v18 offset:34208
    s_waitcnt lgkmcnt(10)
    v_mfma_f32_32x32x16_bf16 v[20:35], v[56:59], v[60:63], v[20:35]
    ds_read_b128 v[56:59], v18 offset:448
    ds_read_b128 v[60:63], v18 offset:34240
    s_waitcnt lgkmcnt(10)
    v_mfma_f32_32x32x16_bf16 v[20:35], v[64:67], v[68:71], v[20:35]
    ds_read_b128 v[64:67], v18 offset:480
    ds_read_b128 v[68:71], v18 offset:34272
    s_waitcnt lgkmcnt(10)
    v_mfma_f32_32x32x16_bf16 v[20:35], v[72:75], v[76:79], v[20:35]
    s_waitcnt lgkmcnt(8)
    v_mfma_f32_32x32x16_bf16 v[20:35], v[80:83], v[84:87], v[20:35]
    s_waitcnt lgkmcnt(6)
    v_mfma_f32_32x32x16_bf16 v[20:35], v[40:43], v[44:47], v[20:35]
    s_waitcnt lgkmcnt(4)
    v_mfma_f32_32x32x16_bf16 v[20:35], v[48:51], v[52:55], v[20:35]
    s_waitcnt lgkmcnt(2)
    v_mfma_f32_32x32x16_bf16 v[20:35], v[56:59], v[60:63], v[20:35]
    s_waitcnt lgkmcnt(0)
    v_mfma_f32_32x32x16_bf16 v[20:35], v[64:67], v[68:71], v[20:35]
    s_nop 11
    v_cvt_pk_bf16_f32 v38, v23, v22
    v_cvt_pk_bf16_f32 v39, v21, v20
    ds_write_b64 v36, v[38:39] offset:512
    v_cvt_pk_bf16_f32 v40, v26, v25
    v_cvt_pk_bf16_f32 v41, v24, v24
    ds_write_b64 v36, v[40:41]
    v_cndmask_b32 v42, v29, 0, vcc
    v_cvt_pk_bf16_f32 v42, v42, v28
    ds_write_b32 v37, v42 offset:764
    v_cvt_pk_bf16_f32 v45, v30, v31
    ds_write_b16 v19, v45 offset:1534
    ds_write_b16_d16_hi v19, v45 offset:1470
    s_and_saveexec_b64 s[6:7], vcc
    v_mov_b32 v46, 0
    v_cvt_pk_bf16_f32 v46, v46, v26
    v_cvt_pk_bf16_f32 v47, v26, v26
    s_sub_u32 s4, s4, 512
    v_mov_b32 v48, s4
    ds_write_b64 v48, v[46:47]
    v_mov_b32 v48, s5
    ds_write_b32 v48, v29 offset:1792
    s_mov_b64 exec, s[6:7]
mg_nm11:
    s_cmp_lt_u32 s47, 4
    s_cbranch_scc1 mg_nw112
    v_and_b32 v16, 31, v0
    v_bfe_u32 v17, v0, 5, 1
    s_lshl_b32 s4, s49, 6
    s_add_u32 s4, s4, 143872
    v_lshl_add_u32 v18, v16, 8, s4
    v_lshl_add_u32 v18, v17, 4, v18
    s_lshl_b32 s4, s49, 10
    s_add_u32 s4, s4, 152064
    v_bfe_u32 v21, v0, 2, 2
    v_lshl_add_u32 v21, v17, 3, v21
    v_lshl_add_u32 v21, v21, 5, s4
    v_and_b32 v22, 1, v0
    v_lshl_add_u32 v22, v22, 9, v21
    v_bfe_u32 v23, v0, 1, 1
    v_lshl_add_u32 v22, v23, 3, v22
    v_bfe_u32 v23, v0, 4, 1
    v_lshl_add_u32 v22, v23, 4, v22
    ds_read_b64_tr_b16 v[24:25], v22
    ds_read_b64_tr_b16 v[26:27], v22 offset:128
    ds_read_b64_tr_b16 v[40:41], v21 offset:24
    ds_read_b64_tr_b16 v[42:43], v21 offset:152
    ds_read_b128 v[44:47], v18
    ds_read_b128 v[48:51], v18 offset:32
    v_bfe_u32 v19, v16, 2, 1
    v_lshrrev_b32 v20, 3, v16
    v_and_b32 v23, 3, v16
    v_lshl_add_u32 v20, v20, 2, v23
    s_cmp_lg_u32 s58, 2
    s_cbranch_scc1 mg_notv13
    v_lshrrev_b32 v19, 4, v16
    v_and_b32 v20, 15, v16
mg_notv13:
    v_mov_b32 v36, 0
    v_mov_b32 v37, 0
    v_mov_b32 v38, 0
    v_mov_b32 v39, 0
    s_cmp_ge_u32 s58, 2
    s_cbranch_scc1 mg_ident14
    s_cmp_lg_u32 s58, 1
    s_cbranch_scc1 mg_bdone15
    s_waitcnt lgkmcnt(3)
    v_mov_b32_dpp v36, v40 quad_perm:[3,3,3,3] row_mask:0xf bank_mask:0xf
    v_mov_b32_dpp v37, v41 quad_perm:[3,3,3,3] row_mask:0xf bank_mask:0xf
    s_waitcnt lgkmcnt(2)
    v_mov_b32_dpp v38, v42 quad_perm:[3,3,3,3] row_mask:0xf bank_mask:0xf
    v_mov_b32_dpp v39, v43 quad_perm:[3,3,3,3] row_mask:0xf bank_mask:0xf
    v_xor_b32 v36, 0x80008000, v36
    v_xor_b32 v37, 0x80008000, v37
    v_xor_b32 v38, 0x80008000, v38
    v_xor_b32 v39, 0x80008000, v39
    s_branch mg_bdone15
mg_ident14:
    v_lshlrev_b32 v28, 3, v17
    v_sub_u32 v23, v20, v28
    v_and_b32 v28, 1, v23
    v_lshlrev_b32 v28, 4, v28
    v_mov_b32 v29, 0x3f80
    v_lshlrev_b32 v29, v28, v29
    v_ashrrev_i32 v23, 1, v23
    v_cmp_eq_u32 vcc, 0, v23
    s_waitcnt lgkmcnt(5)
    s_nop 0
    v_cndmask_b32 v24, 0, v29, vcc
    v_cmp_eq_u32 vcc, 1, v23
    s_nop 1
    v_cndmask_b32 v25, 0, v29, vcc
    v_cmp_eq_u32 vcc, 2, v23
    s_waitcnt lgkmcnt(4)
    s_nop 0
    v_cndmask_b32 v26, 0, v29, vcc
    v_cmp_eq_u32 vcc, 3, v23
    s_nop 1
    v_cndmask_b32 v27, 0, v29, vcc
mg_bdone15:
    v_cmp_eq_u32 vcc, 0, v19
    s_waitcnt lgkmcnt(5)
    s_nop 0
    v_cndmask_b32 v28, 0, v24, vcc
    v_cndmask_b32 v32, v24, 0, vcc
    v_cndmask_b32 v36, 0, v36, vcc
    v_cndmask_b32 v29, 0, v25, vcc
    v_cndmask_b32 v33, v25, 0, vcc
    v_cndmask_b32 v37, 0, v37, vcc
    s_waitcnt lgkmcnt(4)
    v_cndmask_b32 v30, 0, v26, vcc
    v_cndmask_b32 v34, v26, 0, vcc
    v_cndmask_b32 v38, 0, v38, vcc
    v_cndmask_b32 v31, 0, v27, vcc
    v_cndmask_b32 v35, v27, 0, vcc
    v_cndmask_b32 v39, 0, v39, vcc
    s_waitcnt lgkmcnt(1)
    v_mfma_f32_32x32x16_bf16 v[64:79], v[44:47], v[28:31], 0
    s_waitcnt lgkmcnt(0)
    v_mfma_f32_32x32x16_bf16 v[64:79], v[48:51], v[32:35], v[64:79]
    v_mfma_f32_32x32x16_bf16 v[64:79], v[44:47], v[36:39], v[64:79]
    s_cmp_eq_u32 s58, 1
    s_cselect_b32 s4, 27, 99
    v_cmp_eq_u32 vcc, s4, v16
    v_mov_b32 v23, 0x3f803f80
    s_nop 7
    v_cvt_pk_bf16_f32 v80, v64, v65
    v_cvt_pk_bf16_f32 v81, v66, v67
    v_cvt_pk_bf16_f32 v82, v68, v69
    v_cvt_pk_bf16_f32 v83, v70, v71
    v_cvt_pk_bf16_f32 v84, v72, v73
    v_cvt_pk_bf16_f32 v85, v74, v75
    v_cvt_pk_bf16_f32 v86, v76, v77
    v_cvt_pk_bf16_f32 v87, v78, v79
    v_cndmask_b32 v80, v80, v23, vcc
    v_cndmask_b32 v81, v81, v23, vcc
    v_cndmask_b32 v82, v82, v23, vcc
    v_cndmask_b32 v83, v83, v23, vcc
    v_cndmask_b32 v84, v84, v23, vcc
    v_cndmask_b32 v85, v85, v23, vcc
    v_cndmask_b32 v86, v86, v23, vcc
    v_cndmask_b32 v87, v87, v23, vcc
    buffer_store_dwordx4 v[80:83], v3, s[28:31], s59 offen sc1
    buffer_store_dwordx4 v[84:87], v3, s[28:31], s60 offen sc1
    v_mov_b32 v240, 0
    v_mov_b32 v241, 0
    v_dot2c_f32_bf16 v240, v80, v23
    v_dot2c_f32_bf16 v241, v81, v23
    v_dot2c_f32_bf16 v240, v82, v23
    v_dot2c_f32_bf16 v241, v83, v23
    v_dot2c_f32_bf16 v240, v84, v23
    v_dot2c_f32_bf16 v241, v85, v23
    v_dot2c_f32_bf16 v240, v86, v23
    v_dot2c_f32_bf16 v241, v87, v23
    s_nop 2
    v_add_f32 v240, v240, v241
    v_mov_b32 v241, v240
    s_nop 1
    v_permlane32_swap_b32 v240, v241
    v_add_f32 v240, v240, v241
mg_nw112:
    s_waitcnt lgkmcnt(0)
    s_barrier
    s_waitcnt vmcnt(0)
    v_readfirstlane_b32 s51, v238
    v_lshlrev_b32 v8, 4, v0
    v_lshrrev_b32 v9, 3, v0
    v_lshlrev_b32 v10, 15, v9
    v_and_b32 v11, 7, v0
    v_lshl_add_u32 v10, v11, 3, v10
    s_lshl_b32 s37, s57, 7
    s_add_u32 s40, s37, s52
    s_add_u32 s41, s40, 0x200000
    buffer_load_dwordx2 v[24:25], v10, s[28:31], s40 offen sc1
    buffer_load_dwordx2 v[26:27], v10, s[28:31], s40 offen offset:64 sc1
    v_lshlrev_b32 v12, 5, v0
    s_mov_b32 s42, 19267584
    buffer_load_dwordx4 v[16:19], v12, s[28:31], s42 offen sc1
    buffer_load_dwordx4 v[20:23], v12, s[28:31], s42 offen offset:16 sc1
    v_and_b32 v64, 255, v0
    v_lshrrev_b32 v65, 8, v0
    v_lshrrev_b32 v66, 1, v64
    v_lshlrev_b32 v66, 2, v66
    v_mul_u32_u24 v67, 1280, v65
    v_add_u32 v66, v66, v67
    v_add_u32 v66, 133120, v66
    v_and_b32 v67, 1, v0
    v_lshlrev_b32 v67, 4, v67
    v_mul_u32_u24 v68, 12288, v65
    v_lshl_add_u32 v68, v64, 4, v68
    v_add_u32 v69, 1024, v66
    ds_read2_b32 v[72:73], v66 offset0:0 offset1:1
    ds_read2_b32 v[74:75], v66 offset0:2 offset1:3
    ds_read_b32 v76, v66 offset:16
    ds_read2_b32 v[82:83], v66 offset0:128 offset1:129
    ds_read2_b32 v[84:85], v66 offset0:130 offset1:131
    ds_read_b32 v86, v66 offset:528
    ds_read2_b32 v[92:93], v69 offset0:0 offset1:1
    ds_read2_b32 v[94:95], v69 offset0:2 offset1:3
    ds_read_b32 v96, v69 offset:16
    s_waitcnt lgkmcnt(8)
    v_alignbit_b32 v78, v73, v72, v67
    s_waitcnt lgkmcnt(7)
    v_alignbit_b32 v79, v74, v73, v67
    v_alignbit_b32 v80, v75, v74, v67
    s_waitcnt lgkmcnt(6)
    v_alignbit_b32 v81, v76, v75, v67
    ds_write_b128 v68, v[78:81] offset:0
    s_waitcnt lgkmcnt(6)
    v_alignbit_b32 v88, v83, v82, v67
    s_waitcnt lgkmcnt(5)
    v_alignbit_b32 v89, v84, v83, v67
    v_alignbit_b32 v90, v85, v84, v67
    s_waitcnt lgkmcnt(4)
    v_alignbit_b32 v91, v86, v85, v67
    ds_write_b128 v68, v[88:91] offset:4096
    s_waitcnt lgkmcnt(4)
    v_alignbit_b32 v98, v93, v92, v67
    s_waitcnt lgkmcnt(3)
    v_alignbit_b32 v99, v94, v93, v67
    v_alignbit_b32 v100, v95, v94, v67
    s_waitcnt lgkmcnt(2)
    v_alignbit_b32 v101, v96, v95, v67
    v_cmp_gt_u32 vcc, 88, v64
    s_and_saveexec_b64 s[6:7], vcc
    ds_write_b128 v68, v[98:101] offset:8192
    s_mov_b64 exec, s[6:7]
    s_waitcnt lgkmcnt(0)
    s_barrier
    ds_read_b128 v[244:247], v8 offset:0
    ds_read_b128 v[248:251], v8 offset:8192
    ds_read_b128 v[252:255], v8 offset:16384
mg_layer:
    v_bfe_u32 v12, v0, 1, 2
    v_mul_u32_u24 v12, 1312, v12
    v_lshl_add_u32 v12, v9, 4, v12
    v_and_b32 v13, 1, v0
    v_lshl_add_u32 v12, v13, 3, v12
    v_mov_b32 v14, 11392
    ds_read_b32 v62, v14
    ds_read_b32 v63, v14 offset:12288
    s_cmp_ge_u32 s47, 4
    s_cbranch_scc1 mg_h016
    v_and_b32 v48, 31, v0
    v_bfe_u32 v49, v0, 5, 1
    s_lshr_b32 s4, s47, 1
    s_and_b32 s5, s47, 1
    v_lshlrev_b32 v50, 3, v49
    v_sub_u32 v50, v50, v48
    v_lshlrev_b32 v50, 4, v50
    s_mul_i32 s6, s4, 12288
    s_lshl_b32 s7, s5, 8
    s_add_u32 s7, s7, s6
    s_add_u32 s7, s7, 496
    v_add_u32 v50, s7, v50
    v_mul_u32_u24 v51, 1312, v49
    v_lshl_add_u32 v51, v48, 4, v51
    s_mul_i32 s7, s4, 5248
    s_mul_i32 s38, s5, 2624
    s_add_u32 s7, s7, s38
    s_add_u32 s7, s7, 24592
    v_add_u32 v51, s7, v51
    v_bfe_u32 v52, v0, 2, 2
    v_and_b32 v53, 3, v0
    v_bfe_u32 v54, v0, 4, 1
    v_lshlrev_b32 v55, 3, v53
    v_lshl_add_u32 v55, v54, 5, v55
    v_and_b32 v56, 1, v52
    v_mul_u32_u24 v53, 3200, v56
    v_mul_u32_u24 v54, 2176, v56
    v_lshl_add_u32 v56, v49, 3, v52
    s_mul_i32 s7, s4, 12928
    s_add_u32 s7, s7, 35200
    s_lshl_b32 s38, s5, 7
    s_add_u32 s38, s38, s7
    v_lshl_add_u32 v57, v56, 3, v55
    v_add3_u32 v57, s38, v57, v53
    s_lshl_b32 s38, s5, 8
    s_add_u32 s38, s38, s7
    s_add_u32 s38, s38, 6400
    v_lshl_add_u32 v58, v56, 4, v55
    v_add3_u32 v58, s38, v58, v54
    v_sub_u32 v59, v49, v48
    v_lshlrev_b32 v59, 4, v59
    s_lshl_b32 s38, s5, 5
    s_add_u32 s38, s38, s6
    s_add_u32 s39, s38, 10096
    v_add_u32 v59, s39, v59
    v_lshlrev_b32 v60, 1, v49
    v_sub_u32 v60, v60, v48
    v_lshlrev_b32 v60, 3, v60
    s_add_u32 s39, s38, 11128
    v_add_u32 v60, s39, v60
    v_mul_u32_u24 v61, 1088, v49
    v_lshl_add_u32 v61, v48, 4, v61
    s_mul_i32 s7, s47, 8704
    s_add_u32 s7, s7, 0
    v_add_u32 v61, s7, v61
    ds_read_b128 v[168:171], v50 offset:8704
    ds_read_b128 v[172:175], v50 offset:8192
    ds_read_b128 v[176:179], v50 offset:7680
    ds_read_b128 v[180:183], v50 offset:7168
    ds_read_b128 v[184:187], v50 offset:6656
    ds_read_b128 v[188:191], v50 offset:6144
    ds_read_b128 v[192:195], v50 offset:5632
    ds_read_b128 v[196:199], v50 offset:5120
    ds_read_b128 v[200:203], v50 offset:4608
    ds_read_b128 v[204:207], v50 offset:4096
    ds_read_b128 v[208:211], v50 offset:3584
    ds_read_b128 v[212:215], v50 offset:3072
    ds_read_b128 v[216:219], v50 offset:2560
    ds_read_b128 v[220:223], v50 offset:2048
    ds_read_b128 v[224:227], v50 offset:1536
    ds_read_b128 v[228:231], v50 offset:1024
    ds_read_b128 v[232:235], v50 offset:512
    ds_read_b128 v[236:239], v50 offset:0
    s_branch mg_j017
mg_h016:
    v_and_b32 v54, 127, v0
    s_lshr_b32 s4, s49, 1
    s_mul_i32 s5, s4, 5248
    s_mul_i32 s6, s4, 12928
    s_add_u32 s6, s6, 35264
    v_add_u32 v48, 71, v54
    v_and_b32 v49, 3, v48
    v_mul_u32_u24 v49, 1312, v49
    v_lshrrev_b32 v48, 2, v48
    v_lshl_add_u32 v48, v48, 4, v49
    v_add_u32 v50, s5, v48
    v_add_u32 v48, 72, v54
    v_and_b32 v49, 3, v48
    v_mul_u32_u24 v49, 1312, v49
    v_lshrrev_b32 v48, 2, v48
    v_lshl_add_u32 v48, v48, 4, v49
    v_add_u32 v51, s5, v48
    v_add_u32 v48, 73, v54
    v_and_b32 v49, 3, v48
    v_mul_u32_u24 v49, 1312, v49
    v_lshrrev_b32 v48, 2, v48
    v_lshl_add_u32 v48, v48, 4, v49
    v_add_u32 v52, s5, v48
    v_lshl_add_u32 v53, v54, 4, s6
mg_j017:
    s_mov_b32 s4, 0x3b000000
    v_mov_b32 v14, 0x3727c5ac
    s_waitcnt vmcnt(3)
    v_lshlrev_b32 v28, 16, v24
    v_and_b32 v29, 0xffff0000, v24
    v_lshlrev_b32 v30, 16, v25
    v_and_b32 v31, 0xffff0000, v25
    s_waitcnt vmcnt(2)
    v_lshlrev_b32 v32, 16, v26
    v_and_b32 v33, 0xffff0000, v26
    v_lshlrev_b32 v34, 16, v27
    v_and_b32 v35, 0xffff0000, v27
    s_waitcnt vmcnt(1)
    v_mul_f32 v16, s4, v16
    v_mul_f32 v18, s4, v18
    s_waitcnt vmcnt(0)
    v_mul_f32 v20, s4, v20
    v_mul_f32 v22, s4, v22
    v_fma_f32 v17, s4, v17, v14
    v_fma_f32 v19, s4, v19, v14
    v_fma_f32 v21, s4, v21, v14
    v_fma_f32 v23, s4, v23, v14
    v_fma_f32 v17, -v16, v16, v17
    v_fma_f32 v19, -v18, v18, v19
    v_fma_f32 v21, -v20, v20, v21
    v_fma_f32 v23, -v22, v22, v23
    v_max_f32 v17, v17, v14
    v_max_f32 v19, v19, v14
    v_max_f32 v21, v21, v14
    v_max_f32 v23, v23, v14
    v_rsq_f32 v17, v17
    v_rsq_f32 v19, v19
    v_rsq_f32 v21, v21
    v_rsq_f32 v23, v23
    s_lshl_b32 s4, s51, 16
    s_and_b32 s5, s51, 0xffff0000
    v_sub_f32 v36, v28, v16
    v_sub_f32 v37, v29, v18
    v_sub_f32 v38, v30, v20
    v_sub_f32 v39, v31, v22
    v_sub_f32 v40, v32, v16
    v_sub_f32 v41, v33, v18
    v_sub_f32 v42, v34, v20
    v_sub_f32 v43, v35, v22
    v_mul_f32 v36, v36, v17
    v_mul_f32 v37, v37, v19
    v_mul_f32 v38, v38, v21
    v_mul_f32 v39, v39, v23
    v_cvt_pk_bf16_f32 v44, v36, v37
    v_cvt_pk_bf16_f32 v45, v38, v39
    ds_write_b64 v12, v[44:45] offset:24864
    v_mul_f32 v40, v40, v17
    v_mul_f32 v41, v41, v19
    v_mul_f32 v42, v42, v21
    v_mul_f32 v43, v43, v23
    v_cvt_pk_bf16_f32 v46, v40, v41
    v_cvt_pk_bf16_f32 v47, v42, v43
    ds_write_b64 v12, v[46:47] offset:30112
    v_fma_f32 v28, v36, s4, v28
    v_fma_f32 v29, v37, s4, v29
    v_fma_f32 v30, v38, s4, v30
    v_fma_f32 v31, v39, s4, v31
    v_fma_f32 v32, v40, s5, v32
    v_fma_f32 v33, v41, s5, v33
    v_fma_f32 v34, v42, s5, v34
    v_fma_f32 v35, v43, s5, v35
    v_mul_u32_u24 v12, 1088, v11
    v_lshl_add_u32 v12, v9, 4, v12
    v_lshlrev_b32 v13, 3, v0
    v_subrev_u32 v13, 1984, v13
    v_max_i32 v13, 0, v13
    s_waitcnt lgkmcnt(0)
    s_barrier
    s_cmp_ge_u32 s47, 4
    s_cbranch_scc1 mg_help18
    ds_read_b128 v[96:99], v51 offset:272
    ds_read_b128 v[100:103], v51 offset:784
    ds_read_b128 v[104:107], v51 offset:256
    ds_read_b128 v[108:111], v51 offset:768
    s_waitcnt lgkmcnt(3)
    v_mfma_f32_32x32x16_bf16 v[64:79], v[168:171], v[96:99], 0
    ds_read_b128 v[112:115], v51 offset:240
    ds_read_b128 v[116:119], v51 offset:752
    s_waitcnt lgkmcnt(4)
    v_mfma_f32_32x32x16_bf16 v[80:95], v[168:171], v[100:103], 0
    ds_read_b128 v[120:123], v51 offset:224
    ds_read_b128 v[124:127], v51 offset:736
    s_waitcnt lgkmcnt(5)
    v_mfma_f32_32x32x16_bf16 v[64:79], v[172:175], v[104:107], v[64:79]
    ds_read_b128 v[128:131], v51 offset:208
    ds_read_b128 v[132:135], v51 offset:720
    s_waitcnt lgkmcnt(6)
    v_mfma_f32_32x32x16_bf16 v[80:95], v[172:175], v[108:111], v[80:95]
    ds_read_b128 v[136:139], v51 offset:192
    ds_read_b128 v[140:143], v51 offset:704
    s_waitcnt lgkmcnt(7)
    v_mfma_f32_32x32x16_bf16 v[64:79], v[176:179], v[112:115], v[64:79]
    ds_read_b128 v[144:147], v51 offset:176
    ds_read_b128 v[148:151], v51 offset:688
    s_waitcnt lgkmcnt(8)
    v_mfma_f32_32x32x16_bf16 v[80:95], v[176:179], v[116:119], v[80:95]
    ds_read_b128 v[96:99], v51 offset:160
    ds_read_b128 v[100:103], v51 offset:672
    s_waitcnt lgkmcnt(9)
    v_mfma_f32_32x32x16_bf16 v[64:79], v[180:183], v[120:123], v[64:79]
    ds_read_b128 v[104:107], v51 offset:144
    s_waitcnt lgkmcnt(9)
    v_mfma_f32_32x32x16_bf16 v[80:95], v[180:183], v[124:127], v[80:95]
    ds_read_b128 v[108:111], v51 offset:656
    s_waitcnt lgkmcnt(9)
    v_mfma_f32_32x32x16_bf16 v[64:79], v[184:187], v[128:131], v[64:79]
    ds_read_b128 v[112:115], v51 offset:128
    s_waitcnt lgkmcnt(9)
    v_mfma_f32_32x32x16_bf16 v[80:95], v[184:187], v[132:135], v[80:95]
    ds_read_b128 v[116:119], v51 offset:640
    s_waitcnt lgkmcnt(9)
    v_mfma_f32_32x32x16_bf16 v[64:79], v[188:191], v[136:139], v[64:79]
    ds_read_b128 v[120:123], v51 offset:112
    s_waitcnt lgkmcnt(9)
    v_mfma_f32_32x32x16_bf16 v[80:95], v[188:191], v[140:143], v[80:95]
    ds_read_b128 v[124:127], v51 offset:624
    s_waitcnt lgkmcnt(9)
    v_mfma_f32_32x32x16_bf16 v[64:79], v[192:195], v[144:147], v[64:79]
    ds_read_b128 v[128:131], v51 offset:96
    s_waitcnt lgkmcnt(9)
    v_mfma_f32_32x32x16_bf16 v[80:95], v[192:195], v[148:151], v[80:95]
    ds_read_b128 v[132:135], v51 offset:608
    s_waitcnt lgkmcnt(9)
    v_mfma_f32_32x32x16_bf16 v[64:79], v[196:199], v[96:99], v[64:79]
    ds_read_b128 v[136:139], v51 offset:80
    ds_read_b128 v[152:155], v59 offset:512
    s_waitcnt lgkmcnt(10)
    v_mfma_f32_32x32x16_bf16 v[80:95], v[196:199], v[100:103], v[80:95]
    ds_read_b128 v[140:143], v51 offset:592
    ds_read_b128 v[156:159], v59 offset:576
    s_waitcnt lgkmcnt(11)
    v_mfma_f32_32x32x16_bf16 v[64:79], v[200:203], v[104:107], v[64:79]
    ds_read_b128 v[144:147], v51 offset:64
    ds_read_b128 v[160:163], v59 offset:640
    s_waitcnt lgkmcnt(12)
    v_mfma_f32_32x32x16_bf16 v[80:95], v[200:203], v[108:111], v[80:95]
    ds_read_b128 v[148:151], v51 offset:576
    ds_read_b128 v[164:167], v59 offset:704
    s_waitcnt lgkmcnt(13)
    v_mfma_f32_32x32x16_bf16 v[64:79], v[204:207], v[112:115], v[64:79]
    ds_read_b128 v[96:99], v51 offset:48
    ds_read_b128 v[168:171], v59 offset:0
    s_waitcnt lgkmcnt(14)
    v_mfma_f32_32x32x16_bf16 v[80:95], v[204:207], v[116:119], v[80:95]
    ds_read_b128 v[100:103], v51 offset:560
    ds_read_b128 v[172:175], v59 offset:64
    s_waitcnt lgkmcnt(15)
    v_mfma_f32_32x32x16_bf16 v[64:79], v[208:211], v[120:123], v[64:79]
    ds_read_b128 v[104:107], v51 offset:32
    ds_read_b128 v[176:179], v59 offset:128
    s_waitcnt lgkmcnt(15)
    v_mfma_f32_32x32x16_bf16 v[80:95], v[208:211], v[124:127], v[80:95]
    ds_read_b128 v[108:111], v51 offset:544
    ds_read_b128 v[180:183], v59 offset:192
    v_mfma_f32_32x32x16_bf16 v[64:79], v[212:215], v[128:131], v[64:79]
    ds_read_b128 v[112:115], v51 offset:16
    ds_read_b128 v[184:187], v59 offset:256
    s_waitcnt lgkmcnt(15)
    v_mfma_f32_32x32x16_bf16 v[80:95], v[212:215], v[132:135], v[80:95]
    ds_read_b128 v[116:119], v51 offset:528
    ds_read_b128 v[188:191], v59 offset:320
    v_mfma_f32_32x32x16_bf16 v[64:79], v[216:219], v[136:139], v[64:79]
    ds_read_b128 v[120:123], v51 offset:0
    ds_read_b128 v[192:195], v59 offset:384
    v_mfma_f32_32x32x16_bf16 v[80:95], v[216:219], v[140:143], v[80:95]
    ds_read_b128 v[124:127], v51 offset:512
    ds_read_b128 v[196:199], v59 offset:448
    s_waitcnt lgkmcnt(15)
    v_mfma_f32_32x32x16_bf16 v[64:79], v[220:223], v[144:147], v[64:79]
    ds_read_b64 v[200:201], v60 offset:0
    ds_read_b64 v[202:203], v60 offset:8
    ds_read_b64 v[204:205], v60 offset:64
    ds_read_b64 v[206:207], v60 offset:72
    v_mfma_f32_32x32x16_bf16 v[80:95], v[220:223], v[148:151], v[80:95]
    ds_read_b64 v[208:209], v60 offset:128
    ds_read_b64 v[210:211], v60 offset:136
    ds_read_b64 v[212:213], v60 offset:192
    ds_read_b64 v[214:215], v60 offset:200
    v_mfma_f32_32x32x16_bf16 v[64:79], v[224:227], v[96:99], v[64:79]
    s_waitcnt lgkmcnt(15)
    v_mfma_f32_32x32x16_bf16 v[80:95], v[224:227], v[100:103], v[80:95]
    v_mfma_f32_32x32x16_bf16 v[64:79], v[228:231], v[104:107], v[64:79]
    v_mfma_f32_32x32x16_bf16 v[80:95], v[228:231], v[108:111], v[80:95]
    v_mfma_f32_32x32x16_bf16 v[64:79], v[232:235], v[112:115], v[64:79]
    s_waitcnt lgkmcnt(13)
    v_mfma_f32_32x32x16_bf16 v[80:95], v[232:235], v[116:119], v[80:95]
    s_waitcnt lgkmcnt(11)
    v_mfma_f32_32x32x16_bf16 v[64:79], v[236:239], v[120:123], v[64:79]
    s_waitcnt lgkmcnt(9)
    v_mfma_f32_32x32x16_bf16 v[80:95], v[236:239], v[124:127], v[80:95]
    s_waitcnt lgkmcnt(0)
    s_barrier
    ds_read_b64_tr_b16 v[96:97], v57 offset:0
    ds_read_b64_tr_b16 v[98:99], v57 offset:32
    ds_read_b64_tr_b16 v[100:101], v57 offset:256
    ds_read_b64_tr_b16 v[102:103], v57 offset:288
    s_waitcnt lgkmcnt(2)
    v_mfma_f32_32x32x16_bf16 v[64:79], v[96:99], v[152:155], v[64:79]
    ds_read_b64_tr_b16 v[104:105], v57 offset:512
    ds_read_b64_tr_b16 v[106:107], v57 offset:544
    v_mfma_f32_32x32x16_bf16 v[80:95], v[96:99], v[168:171], v[80:95]
    ds_read_b64_tr_b16 v[108:109], v57 offset:768
    ds_read_b64_tr_b16 v[110:111], v57 offset:800
    s_waitcnt lgkmcnt(4)
    v_mfma_f32_32x32x16_bf16 v[64:79], v[100:103], v[156:159], v[64:79]
    ds_read_b64_tr_b16 v[112:113], v57 offset:1024
    ds_read_b64_tr_b16 v[114:115], v57 offset:1056
    v_mfma_f32_32x32x16_bf16 v[80:95], v[100:103], v[172:175], v[80:95]
    ds_read_b64_tr_b16 v[116:117], v57 offset:1280
    ds_read_b64_tr_b16 v[118:119], v57 offset:1312
    s_waitcnt lgkmcnt(6)
    v_mfma_f32_32x32x16_bf16 v[64:79], v[104:107], v[160:163], v[64:79]
    ds_read_b64_tr_b16 v[120:121], v57 offset:1536
    ds_read_b64_tr_b16 v[122:123], v57 offset:1568
    v_mfma_f32_32x32x16_bf16 v[80:95], v[104:107], v[176:179], v[80:95]
    ds_read_b64_tr_b16 v[124:125], v57 offset:1792
    ds_read_b64_tr_b16 v[126:127], v57 offset:1824
    s_waitcnt lgkmcnt(8)
    v_mfma_f32_32x32x16_bf16 v[64:79], v[108:111], v[164:167], v[64:79]
    ds_read_b64_tr_b16 v[128:129], v58 offset:0
    ds_read_b64_tr_b16 v[130:131], v58 offset:64
    v_mfma_f32_32x32x16_bf16 v[80:95], v[108:111], v[180:183], v[80:95]
    ds_read_b64_tr_b16 v[132:133], v58 offset:512
    ds_read_b64_tr_b16 v[134:135], v58 offset:576
    s_waitcnt lgkmcnt(10)
    v_mfma_f32_32x32x16_bf16 v[80:95], v[112:115], v[184:187], v[80:95]
    ds_read_b64_tr_b16 v[136:137], v58 offset:1024
    ds_read_b64_tr_b16 v[138:139], v58 offset:1088
    s_waitcnt lgkmcnt(10)
    v_mfma_f32_32x32x16_bf16 v[80:95], v[116:119], v[188:191], v[80:95]
    ds_read_b64_tr_b16 v[140:141], v58 offset:1536
    ds_read_b64_tr_b16 v[142:143], v58 offset:1600
    ds_read_b64 v[40:41], v13 offset:45952
    ds_read_b64 v[42:43], v13 offset:58880
    s_waitcnt lgkmcnt(12)
    v_mfma_f32_32x32x16_bf16 v[80:95], v[120:123], v[192:195], v[80:95]
    s_waitcnt lgkmcnt(1)
    v_lshlrev_b32 v38, 16, v40
    v_and_b32 v39, 0xffff0000, v40
    v_fmac_f32 v28, v38, v62
    v_fmac_f32 v29, v39, v62
    v_lshlrev_b32 v38, 16, v41
    v_and_b32 v39, 0xffff0000, v41
    v_fmac_f32 v30, v38, v62
    v_fmac_f32 v31, v39, v62
    v_mfma_f32_32x32x16_bf16 v[80:95], v[124:127], v[196:199], v[80:95]
    s_waitcnt lgkmcnt(0)
    v_lshlrev_b32 v38, 16, v42
    v_and_b32 v39, 0xffff0000, v42
    v_fmac_f32 v32, v38, v63
    v_fmac_f32 v33, v39, v63
    v_lshlrev_b32 v38, 16, v43
    v_and_b32 v39, 0xffff0000, v43
    v_fmac_f32 v34, v38, v63
    v_fmac_f32 v35, v39, v63
    v_mfma_f32_32x32x16_bf16 v[80:95], v[128:131], v[200:203], v[80:95]
    s_barrier
    ds_read_b64_tr_b16 v[144:145], v57 offset:2048
    ds_read_b64_tr_b16 v[146:147], v57 offset:2080
    ds_read_b64_tr_b16 v[148:149], v57 offset:2304
    ds_read_b64_tr_b16 v[150:151], v57 offset:2336
    v_mfma_f32_32x32x16_bf16 v[80:95], v[132:135], v[204:207], v[80:95]
    ds_read_b64_tr_b16 v[96:97], v57 offset:2560
    ds_read_b64_tr_b16 v[98:99], v57 offset:2592
    ds_read_b64_tr_b16 v[100:101], v57 offset:2816
    ds_read_b64_tr_b16 v[102:103], v57 offset:2848
    v_mfma_f32_32x32x16_bf16 v[80:95], v[136:139], v[208:211], v[80:95]
    ds_write_b128 v61, v[64:67] offset:0
    v_mfma_f32_32x32x16_bf16 v[80:95], v[140:143], v[212:215], v[80:95]
    ds_write_b128 v61, v[68:71] offset:2176
    s_waitcnt lgkmcnt(8)
    v_mfma_f32_32x32x16_bf16 v[80:95], v[144:147], v[152:155], v[80:95]
    ds_write_b128 v61, v[72:75] offset:4352
    s_waitcnt lgkmcnt(7)
    v_mfma_f32_32x32x16_bf16 v[80:95], v[148:151], v[156:159], v[80:95]
    ds_write_b128 v61, v[76:79] offset:6528
    s_waitcnt lgkmcnt(6)
    v_mfma_f32_32x32x16_bf16 v[80:95], v[96:99], v[160:163], v[80:95]
    s_waitcnt lgkmcnt(4)
    v_mfma_f32_32x32x16_bf16 v[80:95], v[100:103], v[164:167], v[80:95]
    s_nop 11
    ds_write_b128 v61, v[80:83] offset:512
    ds_write_b128 v61, v[84:87] offset:2688
    ds_write_b128 v61, v[88:91] offset:4864
    ds_write_b128 v61, v[92:95] offset:7040
    s_branch mg_epi19
mg_help18:
    s_cmp_lg_u32 s50, 0
    s_cbranch_scc1 mg_nf20
    s_cmp_lg_u32 s47, 4
    s_cbranch_scc1 mg_tp21
    s_lshl_b32 s4, s57, 7
    s_add_u32 s4, s4, 19320832
    v_mov_b32 v4, s94
    v_mov_b32 v5, s92
    v_mov_b32 v6, s94
    v_mov_b32 v7, s92
    s_mov_b64 exec, 0xff
    buffer_store_dwordx4 v[4:7], v3, s[28:31], s4 offen sc1
    s_mov_b64 exec, -1
mg_tp21:
    s_nop 0
    v_lshlrev_b32 v5, 2, v2
    s_mov_b32 exec_hi, 0
    buffer_atomic_add_f32 v240, v5, s[28:31], s61 offen
    s_mov_b64 exec, -1
    s_cmp_lg_u32 s2, 0
    s_cbranch_scc1 mg_nep22
    s_cmp_lg_u32 s47, 6
    s_cbranch_scc1 mg_tp23
    s_lshl_b32 s4, s57, 7
    s_add_u32 s4, s4, 19283968
    v_mov_b32 v4, s94
    v_mov_b32 v5, s92
    v_mov_b32 v6, s94
    v_mov_b32 v7, s92
    s_mov_b64 exec, 0xff
    buffer_store_dwordx4 v[4:7], v3, s[28:31], s4 offen sc1
    s_mov_b64 exec, -1
mg_tp23:
mg_nep22:
    s_bitcmp0_b32 s47, 0
    s_cbranch_scc1 mg_nf20
    s_lshr_b32 s4, s49, 1
    s_lshl_b32 s4, s4, 6
    v_add_u32 v64, s4, v2
    v_lshlrev_b32 v65, 4, v64
    v_mov_b32 v68, -1
    v_mov_b32 v72, 0
    v_mov_b32 v69, -1
    v_mov_b32 v73, 0
    v_mov_b32 v70, -1
    v_mov_b32 v74, 0
    v_mov_b32 v71, -1
    v_mov_b32 v75, 0
    s_mul_i32 s4, s2, 8976
    s_add_u32 s4, s4, 19922944
    s_add_u32 s5, s4, 4096
    buffer_store_dwordx4 v[68:71], v65, s[28:31], s4 offen offset:0 sc1
    buffer_store_dwordx4 v[68:71], v65, s[28:31], s4 offen offset:2048 sc1
    buffer_store_dwordx4 v[68:71], v65, s[28:31], s5 offen offset:0 sc1
    buffer_store_dwordx4 v[68:71], v65, s[28:31], s5 offen offset:2048 sc1
    s_add_u32 s4, s4, 8192
    s_mul_i32 s5, s2, 1088
    s_add_u32 s5, s5, 18874368
    v_cmp_gt_u32 vcc, 68, v64
    s_and_saveexec_b64 s[6:7], vcc
    buffer_store_dwordx4 v[72:75], v65, s[28:31], s5 offen sc1
    v_cmp_gt_u32 vcc, 49, v64
    s_and_b64 exec, exec, vcc
    s_cbranch_execz mg_fx24
    buffer_store_dwordx4 v[68:71], v65, s[28:31], s4 offen sc1
mg_fx24:
    s_mov_b64 exec, -1
mg_nf20:
    s_setprio 1
    ds_read_b64 v[64:65], v50 offset:24584
    ds_read_b128 v[66:69], v51 offset:24576
    ds_read_b64 v[70:71], v52 offset:24576
    ds_read_b64 v[72:73], v50 offset:25096
    ds_read_b128 v[74:77], v51 offset:25088
    ds_read_b64 v[78:79], v52 offset:25088
    s_waitcnt lgkmcnt(5)
    v_lshlrev_b32 v80, 16, v64
    v_and_b32 v81, 0xffff0000, v64
    v_lshlrev_b32 v82, 16, v65
    v_and_b32 v83, 0xffff0000, v65
    s_waitcnt lgkmcnt(4)
    v_lshlrev_b32 v84, 16, v66
    v_and_b32 v85, 0xffff0000, v66
    v_lshlrev_b32 v86, 16, v67
    v_and_b32 v87, 0xffff0000, v67
    v_lshlrev_b32 v88, 16, v68
    v_and_b32 v89, 0xffff0000, v68
    v_lshlrev_b32 v90, 16, v69
    v_and_b32 v91, 0xffff0000, v69
    s_waitcnt lgkmcnt(3)
    v_lshlrev_b32 v92, 16, v70
    v_and_b32 v93, 0xffff0000, v70
    v_lshlrev_b32 v94, 16, v71
    v_and_b32 v95, 0xffff0000, v71
    v_add_f32 v81, v81, v80
    v_add_f32 v82, v82, v81
    v_add_f32 v83, v83, v82
    v_add_f32 v84, v84, v83
    v_add_f32 v85, v85, v84
    v_add_f32 v86, v86, v85
    v_add_f32 v87, v87, v86
    v_add_f32 v88, v88, v87
    v_add_f32 v89, v89, v88
    v_add_f32 v90, v90, v89
    v_add_f32 v91, v91, v90
    v_add_f32 v92, v92, v91
    v_add_f32 v93, v93, v92
    v_add_f32 v94, v94, v93
    v_add_f32 v95, v95, v94
    v_sub_f32 v96, v86, v81
    v_sub_f32 v97, v87, v82
    v_sub_f32 v98, v88, v83
    v_sub_f32 v99, v89, v84
    v_sub_f32 v100, v90, v85
    v_sub_f32 v101, v91, v86
    v_sub_f32 v102, v92, v87
    v_sub_f32 v103, v93, v88
    v_cvt_pk_bf16_f32 v40, v96, v97
    v_cvt_pk_bf16_f32 v41, v98, v99
    v_cvt_pk_bf16_f32 v42, v100, v101
    v_cvt_pk_bf16_f32 v43, v102, v103
    ds_write_b128 v53, v[40:43] offset:0
    v_sub_f32 v104, v85, v82
    v_sub_f32 v105, v86, v83
    v_sub_f32 v106, v87, v84
    v_sub_f32 v107, v88, v85
    v_sub_f32 v108, v89, v86
    v_sub_f32 v109, v90, v87
    v_sub_f32 v110, v91, v88
    v_sub_f32 v111, v92, v89
    v_cvt_pk_bf16_f32 v44, v104, v105
    v_cvt_pk_bf16_f32 v45, v106, v107
    v_cvt_pk_bf16_f32 v46, v108, v109
    v_cvt_pk_bf16_f32 v47, v110, v111
    ds_write_b128 v53, v[44:47] offset:3200
    v_sub_f32 v97, v89, v80
    v_sub_f32 v98, v90, v81
    v_sub_f32 v99, v91, v82
    v_sub_f32 v100, v92, v83
    v_sub_f32 v101, v93, v84
    v_sub_f32 v102, v94, v85
    v_sub_f32 v103, v95, v86
    v_cvt_pk_bf16_f32 v40, v88, v97
    v_cvt_pk_bf16_f32 v41, v98, v99
    v_cvt_pk_bf16_f32 v42, v100, v101
    v_cvt_pk_bf16_f32 v43, v102, v103
    ds_write_b128 v53, v[40:43] offset:6400
    v_sub_f32 v104, v87, v80
    v_sub_f32 v105, v88, v81
    v_sub_f32 v106, v89, v82
    v_sub_f32 v107, v90, v83
    v_sub_f32 v108, v91, v84
    v_sub_f32 v109, v92, v85
    v_sub_f32 v110, v93, v86
    v_sub_f32 v111, v94, v87
    v_cvt_pk_bf16_f32 v44, v104, v105
    v_cvt_pk_bf16_f32 v45, v106, v107
    v_cvt_pk_bf16_f32 v46, v108, v109
    v_cvt_pk_bf16_f32 v47, v110, v111
    ds_write_b128 v53, v[44:47] offset:8576
    v_sub_f32 v97, v87, v80
    v_sub_f32 v98, v88, v81
    v_sub_f32 v99, v89, v82
    v_sub_f32 v100, v90, v83
    v_sub_f32 v101, v91, v84
    v_sub_f32 v102, v92, v85
    v_sub_f32 v103, v93, v86
    v_cvt_pk_bf16_f32 v40, v86, v97
    v_cvt_pk_bf16_f32 v41, v98, v99
    v_cvt_pk_bf16_f32 v42, v100, v101
    v_cvt_pk_bf16_f32 v43, v102, v103
    ds_write_b128 v53, v[40:43] offset:10752
    v_cmp_eq_u32 vcc, 0, v54
    s_and_saveexec_b64 s[6:7], vcc
    v_subrev_u32 v48, 8, v53
    v_cvt_pk_bf16_f32 v96, v84, v85
    v_cvt_pk_bf16_f32 v97, v86, v87
    v_cvt_pk_bf16_f32 v98, v83, v84
    v_cvt_pk_bf16_f32 v99, v85, v86
    ds_write_b32 v48, v96 offset:4
    ds_write_b32 v48, v98 offset:3204
    ds_write_b64 v48, v[96:97] offset:6400
    ds_write_b64 v48, v[98:99] offset:8576
    ds_write_b32 v48, v96 offset:10756
    s_mov_b64 exec, s[6:7]
    s_waitcnt lgkmcnt(0)
    s_setprio 2
    s_barrier
    s_bitcmp1_b32 s47, 0
    s_cbranch_scc1 mg_odd25
    v_lshlrev_b32 v82, 16, v73
    v_and_b32 v83, 0xffff0000, v73
    v_lshlrev_b32 v84, 16, v74
    v_and_b32 v85, 0xffff0000, v74
    v_lshlrev_b32 v86, 16, v75
    v_and_b32 v87, 0xffff0000, v75
    v_lshlrev_b32 v88, 16, v76
    v_and_b32 v89, 0xffff0000, v76
    v_lshlrev_b32 v90, 16, v77
    v_and_b32 v91, 0xffff0000, v77
    v_lshlrev_b32 v92, 16, v78
    v_and_b32 v93, 0xffff0000, v78
    v_add_f32 v83, v83, v82
    v_add_f32 v84, v84, v83
    v_add_f32 v85, v85, v84
    v_add_f32 v86, v86, v85
    v_add_f32 v87, v87, v86
    v_add_f32 v88, v88, v87
    v_add_f32 v89, v89, v88
    v_add_f32 v90, v90, v89
    v_add_f32 v91, v91, v90
    v_add_f32 v92, v92, v91
    v_add_f32 v93, v93, v92
    v_sub_f32 v97, v87, v82
    v_sub_f32 v98, v88, v83
    v_sub_f32 v99, v89, v84
    v_sub_f32 v100, v90, v85
    v_sub_f32 v101, v91, v86
    v_sub_f32 v102, v92, v87
    v_sub_f32 v103, v93, v88
    v_cvt_pk_bf16_f32 v40, v86, v97
    v_cvt_pk_bf16_f32 v41, v98, v99
    v_cvt_pk_bf16_f32 v42, v100, v101
    v_cvt_pk_bf16_f32 v43, v102, v103
    ds_write_b128 v53, v[40:43] offset:2048
    v_sub_f32 v104, v85, v82
    v_sub_f32 v105, v86, v83
    v_sub_f32 v106, v87, v84
    v_sub_f32 v107, v88, v85
    v_sub_f32 v108, v89, v86
    v_sub_f32 v109, v90, v87
    v_sub_f32 v110, v91, v88
    v_sub_f32 v111, v92, v89
    v_cvt_pk_bf16_f32 v44, v104, v105
    v_cvt_pk_bf16_f32 v45, v106, v107
    v_cvt_pk_bf16_f32 v46, v108, v109
    v_cvt_pk_bf16_f32 v47, v110, v111
    ds_write_b128 v53, v[44:47] offset:5248
    s_waitcnt lgkmcnt(0)
mg_tq28:
    s_barrier
    s_branch mg_dd26
mg_odd25:
    s_cmp_lg_u32 s50, 0
    s_cbranch_scc1 mg_tq28
    s_lshr_b32 s4, s49, 1
    s_lshl_b32 s4, s4, 14
    s_add_u32 s4, s4, 19320832
    s_add_u32 s6, s4, 8192
    v_lshlrev_b32 v5, 7, v2
    s_mov_b32 s5, 0x40000
    buffer_load_dword v4, v5, s[28:31], s4 offen sc1
    buffer_load_dword v6, v5, s[28:31], s6 offen sc1
    s_barrier
mg_tl27:
    s_waitcnt vmcnt(1)
    v_xor_b32 v4, s94, v4
    s_waitcnt vmcnt(0)
    v_xor_b32 v6, s94, v6
    v_or_b32 v4, v4, v6
    v_cmp_ne_u32 vcc, 0, v4
    s_cbranch_vccz mg_dd26
    s_sub_u32 s5, s5, 1
    s_cbranch_scc1 mg_dd26
    buffer_load_dword v4, v5, s[28:31], s4 offen sc1
    buffer_load_dword v6, v5, s[28:31], s6 offen sc1
    s_branch mg_tl27
mg_dd26:
    s_setprio 0
    ds_read_b64 v[40:41], v13 offset:45952
    ds_read_b64 v[42:43], v13 offset:58880
    s_waitcnt lgkmcnt(1)
    v_lshlrev_b32 v38, 16, v40
    v_and_b32 v39, 0xffff0000, v40
    v_fmac_f32 v28, v38, v62
    v_fmac_f32 v29, v39, v62
    v_lshlrev_b32 v38, 16, v41
    v_and_b32 v39, 0xffff0000, v41
    v_fmac_f32 v30, v38, v62
    v_fmac_f32 v31, v39, v62
    s_waitcnt lgkmcnt(0)
    v_lshlrev_b32 v38, 16, v42
    v_and_b32 v39, 0xffff0000, v42
    v_fmac_f32 v32, v38, v63
    v_fmac_f32 v33, v39, v63
    v_lshlrev_b32 v38, 16, v43
    v_and_b32 v39, 0xffff0000, v43
    v_fmac_f32 v34, v38, v63
    v_fmac_f32 v35, v39, v63
mg_epi19:
    s_waitcnt lgkmcnt(0)
    s_barrier
    ds_read_b128 v[48:51], v12 offset:0
    ds_read_b128 v[52:55], v12 offset:8704
    ds_read_b128 v[56:59], v12 offset:17408
    ds_read_b128 v[60:63], v12 offset:26112
    s_waitcnt lgkmcnt(3)
    v_pk_add_f32 v[28:29], v[28:29], v[48:49]
    v_pk_add_f32 v[30:31], v[30:31], v[50:51]
    s_waitcnt lgkmcnt(2)
    v_pk_add_f32 v[28:29], v[28:29], v[52:53]
    v_pk_add_f32 v[30:31], v[30:31], v[54:55]
    v_cvt_pk_bf16_f32 v44, v28, v29
    v_cvt_pk_bf16_f32 v45, v30, v31
    buffer_store_dwordx2 v[44:45], v10, s[28:31], s41 offen offset:0 sc1
    s_waitcnt lgkmcnt(1)
    v_pk_add_f32 v[32:33], v[32:33], v[56:57]
    v_pk_add_f32 v[34:35], v[34:35], v[58:59]
    s_waitcnt lgkmcnt(0)
    v_pk_add_f32 v[32:33], v[32:33], v[60:61]
    v_pk_add_f32 v[34:35], v[34:35], v[62:63]
    v_cvt_pk_bf16_f32 v46, v32, v33
    v_cvt_pk_bf16_f32 v47, v34, v35
    buffer_store_dwordx2 v[46:47], v10, s[28:31], s41 offen offset:64 sc1
    s_cmp_lg_u32 s50, 0
    s_cbranch_scc1 mg_nd
    s_waitcnt vmcnt(0)
mg_nd:
    s_barrier
    s_cmp_lg_u32 s47, 0
    s_cbranch_scc1 mg_na29
    s_bfe_u32 s4, s2, 0x30003
    s_lshl_b32 s4, s4, 8
    s_add_u32 s4, s4, s56
    v_mov_b32 v4, 1
    v_lshlrev_b32 v5, 11, v2
    s_mov_b64 exec, 0xff
    buffer_atomic_add v4, v5, s[28:31], s4 offen sc1
    s_mov_b64 exec, -1
mg_na29:
    s_cmp_lg_u32 s50, 0
    s_cbranch_scc1 mg_nw
    s_lshr_b32 s4, s2, 4
    s_mul_i32 s4, s4, 98304
    s_mul_i32 s5, s47, 12288
    s_add_u32 s4, s4, s5
    s_add_u32 s4, s4, 16777216
    s_add_u32 m0, s5, 65536
    s_nop 0
    buffer_load_dwordx4 v3, s[28:31], s4 offen offset:1024 sc1 lds
    buffer_load_dwordx4 v3, s[28:31], s4 offen offset:2048 sc1 lds
    s_add_u32 s4, s4, 3072
    s_add_u32 m0, s5, 68608
    s_nop 0
    buffer_load_dwordx4 v3, s[28:31], s4 offen offset:1024 sc1 lds
    buffer_load_dwordx4 v3, s[28:31], s4 offen offset:2048 sc1 lds
    s_add_u32 s4, s4, 3072
    s_add_u32 m0, s5, 71680
    s_nop 0
    buffer_load_dwordx4 v3, s[28:31], s4 offen offset:1024 sc1 lds
    buffer_load_dwordx4 v3, s[28:31], s4 offen offset:2048 sc1 lds
    s_add_u32 s4, s4, 3072
    s_add_u32 m0, s5, 74752
    s_nop 0
    buffer_load_dwordx4 v3, s[28:31], s4 offen offset:1024 sc1 lds
    buffer_load_dwordx4 v3, s[28:31], s4 offen offset:2048 sc1 lds
    s_cmp_lt_u32 s47, 4
    s_cbranch_scc1 mg_nw
    s_lshr_b32 s43, s2, 6
    s_lshl_b32 s43, s43, 2
    s_add_u32 s43, s43, s49
    s_lshl_b32 s43, s43, 15
    s_add_u32 s43, s43, 18350080
    buffer_load_dwordx4 v[112:115], v3, s[28:31], s43 offen offset:0 sc1
    buffer_load_dwordx4 v[116:119], v3, s[28:31], s43 offen offset:1024 sc1
    buffer_load_dwordx4 v[120:123], v3, s[28:31], s43 offen offset:2048 sc1
    buffer_load_dwordx4 v[124:127], v3, s[28:31], s43 offen offset:3072 sc1
    s_add_u32 s43, s43, 4096
    buffer_load_dwordx4 v[128:131], v3, s[28:31], s43 offen offset:0 sc1
    buffer_load_dwordx4 v[132:135], v3, s[28:31], s43 offen offset:1024 sc1
    buffer_load_dwordx4 v[136:139], v3, s[28:31], s43 offen offset:2048 sc1
    buffer_load_dwordx4 v[140:143], v3, s[28:31], s43 offen offset:3072 sc1
    s_add_u32 s43, s43, 4096
    buffer_load_dwordx4 v[144:147], v3, s[28:31], s43 offen offset:0 sc1
    buffer_load_dwordx4 v[148:151], v3, s[28:31], s43 offen offset:1024 sc1
    buffer_load_dwordx4 v[152:155], v3, s[28:31], s43 offen offset:2048 sc1
    buffer_load_dwordx4 v[156:159], v3, s[28:31], s43 offen offset:3072 sc1
    s_add_u32 s43, s43, 4096
    buffer_load_dwordx4 v[160:163], v3, s[28:31], s43 offen offset:0 sc1
    buffer_load_dwordx4 v[164:167], v3, s[28:31], s43 offen offset:1024 sc1
    buffer_load_dwordx4 v[168:171], v3, s[28:31], s43 offen offset:2048 sc1
    buffer_load_dwordx4 v[172:175], v3, s[28:31], s43 offen offset:3072 sc1
    s_add_u32 s43, s43, 4096
    s_waitcnt vmcnt(16)
mg_nw:
    s_and_b32 s3, s2, 7
    s_lshl_b32 s3, s3, 1
    s_bfe_u32 s4, s2, 0x10003
    s_add_u32 s32, s3, s4
    s_lshr_b32 s33, s2, 4
    s_and_b32 s35, s33, 7
    s_lshl_b32 s36, s32, 2
    s_add_u32 s36, s36, s49
    s_lshl_b32 s37, s36, 15
    s_add_u32 s37, s37, s52
    s_add_u32 s37, s37, 0x200000
    s_lshl_b32 s42, s49, 14
    v_bfe_u32 v9, v0, 5, 1
    v_and_b32 v8, 31, v0
    s_cmp_ge_u32 s47, 4
    s_cbranch_scc1 mg_hs30
    v_bfe_u32 v6, v0, 2, 2
    v_lshl_add_u32 v6, v9, 2, v6
    v_lshlrev_b32 v6, 6, v6
    v_bfe_u32 v7, v0, 4, 1
    v_lshl_add_u32 v6, v7, 5, v6
    v_and_b32 v7, 3, v0
    v_lshl_add_u32 v6, v7, 3, v6
    v_add_u32 v6, s42, v6
    v_lshl_add_u32 v7, v9, 5, v8
    v_lshl_add_u32 v7, v7, 6, s42
    v_bfe_u32 v13, v0, 1, 2
    v_lshl_add_u32 v7, v13, 4, v7
    v_mov_b32 v12, 0
    v_mov_b32 v13, 0
    s_lshl_b32 s38, s36, 16
    s_lshl_b32 s5, s33, 12
    s_add_u32 s38, s38, s5
    s_add_u32 s38, s38, s55
    s_lshl_b32 s39, s36, 11
    s_add_u32 s39, s39, s62
    s_lshl_b32 s5, s33, 7
    s_add_u32 s39, s39, s5
    s_add_u32 s40, s5, 19402752
    s_and_b32 s4, s2, 7
    s_lshl_b32 s4, s4, 12
    s_add_u32 s4, s4, 19320836
    v_lshlrev_b32 v5, 7, v8
    buffer_load_dword v4, v5, s[28:31], s4 offen sc1
    s_waitcnt vmcnt(0)
    v_cmp_ne_u32 vcc, s92, v4
    s_cmp_eq_u64 vcc, 0
    s_cselect_b32 s93, 1, 0
    s_branch mg_hse31
mg_hs30:
    s_and_b32 s5, s49, 1
    s_lshr_b32 s6, s49, 1
    v_and_b32 v14, 15, v0
    v_bfe_u32 v15, v0, 4, 1
    s_lshl_b32 s4, s5, 8
    s_add_u32 s4, s4, 4096
    v_lshl_add_u32 v12, v14, 4, s4
    v_lshl_add_u32 v12, v15, 9, v12
    v_lshl_add_u32 v12, v9, 10, v12
    v_bfe_u32 v11, v0, 2, 2
    v_lshl_add_u32 v11, v15, 2, v11
    s_lshl_b32 s4, s6, 1
    v_bfe_u32 v13, v0, 1, 1
    v_or_b32 v13, s4, v13
    v_lshrrev_b32 v15, 1, v11
    v_xor_b32 v13, v13, v15
    v_lshl_add_u32 v11, v9, 4, v11
    v_lshlrev_b32 v11, 6, v11
    v_lshl_add_u32 v11, v13, 4, v11
    v_and_b32 v13, 1, v0
    v_lshl_add_u32 v11, v13, 3, v11
    s_lshl_b32 s4, s5, 11
    s_add_u32 s4, s4, 0
    v_add_u32 v14, s4, v11
    s_lshl_b32 s4, s33, 4
    s_add_u32 s4, s4, s32
    s_mul_i32 s4, s4, 4352
    s_add_u32 s4, s4, s63
    s_lshl_b32 s46, s49, 10
    s_add_u32 s46, s46, s4
    s_lshl_b32 s44, s49, 6
    s_add_u32 s44, s44, s4
    s_add_u32 s44, s44, 4096
    v_mov_b32 v80, 0x3f803f80
    v_mov_b32 v81, 0x3f803f80
    v_mov_b32 v82, 0x3f803f80
    v_mov_b32 v83, 0x3f803f80
mg_hse31:
    s_cmp_lg_u32 s47, 0
    s_cbranch_scc1 mg_np32
    s_and_b32 s4, s2, 7
    s_lshl_b32 s4, s4, 11
    s_add_u32 s4, s4, s56
    v_lshlrev_b32 v5, 8, v2
    s_mov_b64 exec, 0xff
    s_mov_b32 s5, 0x40000
mg_pl33:
    s_sleep 4
    buffer_load_dword v4, v5, s[28:31], s4 offen sc1
    s_sub_u32 s5, s5, 1
    s_cbranch_scc1 mg_po34
    s_waitcnt vmcnt(0)
    v_cmp_ne_u32 vcc, 32, v4
    s_cbranch_vccnz mg_pl33
mg_po34:
    s_mov_b64 exec, -1
mg_np32:
    s_add_u32 s56, s56, 16384
    s_barrier
    s_cmp_ge_u32 s47, 4
    s_cbranch_scc1 mg_H35
    s_mov_b32 s46, 0
mg_rs37:
    s_add_u32 s44, s35, 0
    s_and_b32 s44, s44, 7
    s_lshl_b32 s44, s44, 12
    s_add_u32 m0, s42, 0
    s_add_u32 s44, s44, s37
    buffer_load_dwordx4 v3, s[28:31], s44 offen offset:0 sc1 lds
    buffer_load_dwordx4 v3, s[28:31], s44 offen offset:1024 sc1 lds
    buffer_load_dwordx4 v3, s[28:31], s44 offen offset:2048 sc1 lds
    buffer_load_dwordx4 v3, s[28:31], s44 offen offset:3072 sc1 lds
    s_add_u32 s44, s35, 1
    s_and_b32 s44, s44, 7
    s_lshl_b32 s44, s44, 12
    s_add_u32 m0, s42, 4096
    s_add_u32 s44, s44, s37
    buffer_load_dwordx4 v3, s[28:31], s44 offen offset:0 sc1 lds
    buffer_load_dwordx4 v3, s[28:31], s44 offen offset:1024 sc1 lds
    buffer_load_dwordx4 v3, s[28:31], s44 offen offset:2048 sc1 lds
    buffer_load_dwordx4 v3, s[28:31], s44 offen offset:3072 sc1 lds
    s_add_u32 s44, s35, 2
    s_and_b32 s44, s44, 7
    s_lshl_b32 s44, s44, 12
    s_add_u32 m0, s42, 8192
    s_add_u32 s44, s44, s37
    buffer_load_dwordx4 v3, s[28:31], s44 offen offset:0 sc1 lds
    buffer_load_dwordx4 v3, s[28:31], s44 offen offset:1024 sc1 lds
    buffer_load_dwordx4 v3, s[28:31], s44 offen offset:2048 sc1 lds
    buffer_load_dwordx4 v3, s[28:31], s44 offen offset:3072 sc1 lds
    s_add_u32 s44, s35, 3
    s_and_b32 s44, s44, 7
    s_lshl_b32 s44, s44, 12
    s_add_u32 m0, s42, 12288
    s_add_u32 s44, s44, s37
    buffer_load_dwordx4 v3, s[28:31], s44 offen offset:0 sc1 lds
    buffer_load_dwordx4 v3, s[28:31], s44 offen offset:1024 sc1 lds
    buffer_load_dwordx4 v3, s[28:31], s44 offen offset:2048 sc1 lds
    buffer_load_dwordx4 v3, s[28:31], s44 offen offset:3072 sc1 lds
    s_waitcnt vmcnt(16)
    v_lshlrev_b32 v4, 4, v9
    v_lshlrev_b32 v5, 2, v8
    v_add_u32 v5, 4096, v5
    s_add_u32 s45, s35, 0
    s_and_b32 s45, s45, 7
    s_mul_i32 s45, s45, 12288
    s_add_u32 s45, s45, 65536
    v_add_u32 v10, s45, v3
    ds_read_b128 v[192:195], v10 offset:1024
    ds_read_b128 v[196:199], v10 offset:2048
    ds_read_b128 v[200:203], v10 offset:4096
    ds_read_b128 v[204:207], v10 offset:5120
    ds_read_b128 v[208:211], v10 offset:7168
    ds_read_b128 v[212:215], v10 offset:8192
    s_waitcnt vmcnt(15)
    ds_read_b64_tr_b16 v[64:65], v6 offset:0
    ds_read_b64_tr_b16 v[66:67], v6 offset:512
    s_waitcnt vmcnt(14)
    ds_read_b64_tr_b16 v[68:69], v6 offset:1024
    ds_read_b64_tr_b16 v[70:71], v6 offset:1536
    s_waitcnt vmcnt(13)
    ds_read_b64_tr_b16 v[72:73], v6 offset:2048
    ds_read_b64_tr_b16 v[74:75], v6 offset:2560
    s_waitcnt lgkmcnt(4)
    v_mfma_f32_32x32x16_bf16 v[16:31], v[192:195], v[64:67], 0
    ds_read_b128 v[216:219], v10 offset:10240
    ds_read_b128 v[220:223], v10 offset:11264
    s_add_u32 s44, s35, 4
    s_and_b32 s44, s44, 7
    s_lshl_b32 s44, s44, 12
    s_add_u32 m0, s42, 0
    s_add_u32 s44, s44, s37
    buffer_load_dwordx4 v3, s[28:31], s44 offen offset:0 sc1 lds
    v_mfma_f32_32x32x16_bf16 v[32:47], v[64:67], v[196:199], 0
    s_waitcnt vmcnt(13)
    ds_read_b64_tr_b16 v[76:77], v6 offset:3072
    ds_read_b64_tr_b16 v[78:79], v6 offset:3584
    s_waitcnt lgkmcnt(6)
    v_mfma_f32_32x32x16_bf16 v[16:31], v[200:203], v[68:71], v[16:31]
    s_add_u32 s45, s35, 1
    s_and_b32 s45, s45, 7
    s_mul_i32 s45, s45, 12288
    s_add_u32 s45, s45, 65536
    v_add_u32 v11, s45, v3
    ds_read_b128 v[192:195], v11 offset:1024
    ds_read_b128 v[196:199], v11 offset:2048
    buffer_load_dwordx4 v3, s[28:31], s44 offen offset:1024 sc1 lds
    v_mfma_f32_32x32x16_bf16 v[32:47], v[68:71], v[204:207], v[32:47]
    s_waitcnt vmcnt(13)
    ds_read_b64_tr_b16 v[80:81], v6 offset:4096
    ds_read_b64_tr_b16 v[82:83], v6 offset:4608
    s_waitcnt lgkmcnt(8)
    v_mfma_f32_32x32x16_bf16 v[16:31], v[208:211], v[72:75], v[16:31]
    ds_read_b128 v[200:203], v11 offset:4096
    ds_read_b128 v[204:207], v11 offset:5120
    buffer_load_dwordx4 v3, s[28:31], s44 offen offset:2048 sc1 lds
    v_mfma_f32_32x32x16_bf16 v[32:47], v[72:75], v[212:215], v[32:47]
    s_waitcnt vmcnt(13)
    ds_read_b64_tr_b16 v[84:85], v6 offset:5120
    ds_read_b64_tr_b16 v[86:87], v6 offset:5632
    s_waitcnt lgkmcnt(8)
    v_mfma_f32_32x32x16_bf16 v[16:31], v[216:219], v[76:79], v[16:31]
    ds_read_b128 v[208:211], v11 offset:7168
    ds_read_b128 v[212:215], v11 offset:8192
    buffer_load_dwordx4 v3, s[28:31], s44 offen offset:3072 sc1 lds
    v_mfma_f32_32x32x16_bf16 v[32:47], v[76:79], v[220:223], v[32:47]
    s_waitcnt vmcnt(13)
    ds_read_b64_tr_b16 v[88:89], v6 offset:6144
    ds_read_b64_tr_b16 v[90:91], v6 offset:6656
    s_waitcnt lgkmcnt(8)
    v_mfma_f32_32x32x16_bf16 v[16:31], v[192:195], v[80:83], v[16:31]
    ds_read_b128 v[216:219], v11 offset:10240
    ds_read_b128 v[220:223], v11 offset:11264
    s_add_u32 s44, s35, 5
    s_and_b32 s44, s44, 7
    s_lshl_b32 s44, s44, 12
    s_add_u32 m0, s42, 4096
    s_add_u32 s44, s44, s37
    buffer_load_dwordx4 v3, s[28:31], s44 offen offset:0 sc1 lds
    v_mfma_f32_32x32x16_bf16 v[32:47], v[80:83], v[196:199], v[32:47]
    s_waitcnt vmcnt(13)
    ds_read_b64_tr_b16 v[92:93], v6 offset:7168
    ds_read_b64_tr_b16 v[94:95], v6 offset:7680
    s_waitcnt lgkmcnt(8)
    v_mfma_f32_32x32x16_bf16 v[16:31], v[200:203], v[84:87], v[16:31]
    s_add_u32 s45, s35, 2
    s_and_b32 s45, s45, 7
    s_mul_i32 s45, s45, 12288
    s_add_u32 s45, s45, 65536
    v_add_u32 v10, s45, v3
    ds_read_b128 v[192:195], v10 offset:1024
    ds_read_b128 v[196:199], v10 offset:2048
    buffer_load_dwordx4 v3, s[28:31], s44 offen offset:1024 sc1 lds
    v_mfma_f32_32x32x16_bf16 v[32:47], v[84:87], v[204:207], v[32:47]
    s_waitcnt vmcnt(13)
    ds_read_b64_tr_b16 v[96:97], v6 offset:8192
    ds_read_b64_tr_b16 v[98:99], v6 offset:8704
    s_waitcnt lgkmcnt(8)
    v_mfma_f32_32x32x16_bf16 v[16:31], v[208:211], v[88:91], v[16:31]
    ds_read_b128 v[200:203], v10 offset:4096
    ds_read_b128 v[204:207], v10 offset:5120
    buffer_load_dwordx4 v3, s[28:31], s44 offen offset:2048 sc1 lds
    v_mfma_f32_32x32x16_bf16 v[32:47], v[88:91], v[212:215], v[32:47]
    s_waitcnt vmcnt(13)
    ds_read_b64_tr_b16 v[100:101], v6 offset:9216
    ds_read_b64_tr_b16 v[102:103], v6 offset:9728
    v_dot2c_f32_bf16 v12, v64, v64
    v_dot2c_f32_bf16 v13, v65, v65
    v_dot2c_f32_bf16 v12, v66, v66
    v_dot2c_f32_bf16 v13, v67, v67
    v_dot2c_f32_bf16 v12, v68, v68
    v_dot2c_f32_bf16 v13, v69, v69
    v_dot2c_f32_bf16 v12, v70, v70
    v_dot2c_f32_bf16 v13, v71, v71
    v_dot2c_f32_bf16 v12, v72, v72
    v_dot2c_f32_bf16 v13, v73, v73
    v_dot2c_f32_bf16 v12, v74, v74
    v_dot2c_f32_bf16 v13, v75, v75
    v_dot2c_f32_bf16 v12, v76, v76
    v_dot2c_f32_bf16 v13, v77, v77
    v_dot2c_f32_bf16 v12, v78, v78
    v_dot2c_f32_bf16 v13, v79, v79
    v_dot2c_f32_bf16 v12, v80, v80
    v_dot2c_f32_bf16 v13, v81, v81
    v_dot2c_f32_bf16 v12, v82, v82
    v_dot2c_f32_bf16 v13, v83, v83
    v_dot2c_f32_bf16 v12, v84, v84
    v_dot2c_f32_bf16 v13, v85, v85
    v_dot2c_f32_bf16 v12, v86, v86
    v_dot2c_f32_bf16 v13, v87, v87
    v_dot2c_f32_bf16 v12, v88, v88
    v_dot2c_f32_bf16 v13, v89, v89
    v_dot2c_f32_bf16 v12, v90, v90
    v_dot2c_f32_bf16 v13, v91, v91
    s_waitcnt lgkmcnt(8)
    v_mfma_f32_32x32x16_bf16 v[16:31], v[216:219], v[92:95], v[16:31]
    ds_read_b128 v[208:211], v10 offset:7168
    ds_read_b128 v[212:215], v10 offset:8192
    buffer_load_dwordx4 v3, s[28:31], s44 offen offset:3072 sc1 lds
    v_mfma_f32_32x32x16_bf16 v[32:47], v[92:95], v[220:223], v[32:47]
    s_waitcnt vmcnt(13)
    ds_read_b64_tr_b16 v[104:105], v6 offset:10240
    ds_read_b64_tr_b16 v[106:107], v6 offset:10752
    s_waitcnt lgkmcnt(8)
    v_mfma_f32_32x32x16_bf16 v[16:31], v[192:195], v[96:99], v[16:31]
    ds_read_b128 v[216:219], v10 offset:10240
    ds_read_b128 v[220:223], v10 offset:11264
    s_add_u32 s44, s35, 6
    s_and_b32 s44, s44, 7
    s_lshl_b32 s44, s44, 12
    s_add_u32 m0, s42, 8192
    s_add_u32 s44, s44, s37
    buffer_load_dwordx4 v3, s[28:31], s44 offen offset:0 sc1 lds
    v_mfma_f32_32x32x16_bf16 v[32:47], v[96:99], v[196:199], v[32:47]
    s_waitcnt vmcnt(13)
    ds_read_b64_tr_b16 v[108:109], v6 offset:11264
    ds_read_b64_tr_b16 v[110:111], v6 offset:11776
    s_waitcnt lgkmcnt(8)
    v_mfma_f32_32x32x16_bf16 v[16:31], v[200:203], v[100:103], v[16:31]
    s_add_u32 s45, s35, 3
    s_and_b32 s45, s45, 7
    s_mul_i32 s45, s45, 12288
    s_add_u32 s45, s45, 65536
    v_add_u32 v11, s45, v3
    ds_read_b128 v[192:195], v11 offset:1024
    ds_read_b128 v[196:199], v11 offset:2048
    buffer_load_dwordx4 v3, s[28:31], s44 offen offset:1024 sc1 lds
    v_mfma_f32_32x32x16_bf16 v[32:47], v[100:103], v[204:207], v[32:47]
    s_waitcnt vmcnt(13)
    ds_read_b64_tr_b16 v[112:113], v6 offset:12288
    ds_read_b64_tr_b16 v[114:115], v6 offset:12800
    s_waitcnt lgkmcnt(8)
    v_mfma_f32_32x32x16_bf16 v[16:31], v[208:211], v[104:107], v[16:31]
    ds_read_b128 v[200:203], v11 offset:4096
    ds_read_b128 v[204:207], v11 offset:5120
    buffer_load_dwordx4 v3, s[28:31], s44 offen offset:2048 sc1 lds
    v_mfma_f32_32x32x16_bf16 v[32:47], v[104:107], v[212:215], v[32:47]
    s_waitcnt vmcnt(13)
    ds_read_b64_tr_b16 v[116:117], v6 offset:13312
    ds_read_b64_tr_b16 v[118:119], v6 offset:13824
    s_waitcnt lgkmcnt(8)
    v_mfma_f32_32x32x16_bf16 v[16:31], v[216:219], v[108:111], v[16:31]
    ds_read_b128 v[208:211], v11 offset:7168
    ds_read_b128 v[212:215], v11 offset:8192
    buffer_load_dwordx4 v3, s[28:31], s44 offen offset:3072 sc1 lds
    v_mfma_f32_32x32x16_bf16 v[32:47], v[108:111], v[220:223], v[32:47]
    s_waitcnt vmcnt(13)
    ds_read_b64_tr_b16 v[120:121], v6 offset:14336
    ds_read_b64_tr_b16 v[122:123], v6 offset:14848
    s_waitcnt lgkmcnt(8)
    v_mfma_f32_32x32x16_bf16 v[16:31], v[192:195], v[112:115], v[16:31]
    ds_read_b128 v[216:219], v11 offset:10240
    ds_read_b128 v[220:223], v11 offset:11264
    s_add_u32 s44, s35, 7
    s_and_b32 s44, s44, 7
    s_lshl_b32 s44, s44, 12
    s_add_u32 m0, s42, 12288
    s_add_u32 s44, s44, s37
    buffer_load_dwordx4 v3, s[28:31], s44 offen offset:0 sc1 lds
    v_mfma_f32_32x32x16_bf16 v[32:47], v[112:115], v[196:199], v[32:47]
    s_waitcnt vmcnt(13)
    ds_read_b64_tr_b16 v[124:125], v6 offset:15360
    ds_read_b64_tr_b16 v[126:127], v6 offset:15872
    s_waitcnt lgkmcnt(8)
    v_mfma_f32_32x32x16_bf16 v[16:31], v[200:203], v[116:119], v[16:31]
    s_add_u32 s45, s35, 4
    s_and_b32 s45, s45, 7
    s_mul_i32 s45, s45, 12288
    s_add_u32 s45, s45, 65536
    v_add_u32 v10, s45, v3
    ds_read_b128 v[192:195], v10 offset:1024
    ds_read_b128 v[196:199], v10 offset:2048
    buffer_load_dwordx4 v3, s[28:31], s44 offen offset:1024 sc1 lds
    v_mfma_f32_32x32x16_bf16 v[32:47], v[116:119], v[204:207], v[32:47]
    s_waitcnt vmcnt(13)
    ds_read_b64_tr_b16 v[128:129], v6 offset:0
    ds_read_b64_tr_b16 v[130:131], v6 offset:512
    s_waitcnt lgkmcnt(8)
    v_mfma_f32_32x32x16_bf16 v[16:31], v[208:211], v[120:123], v[16:31]
    ds_read_b128 v[200:203], v10 offset:4096
    ds_read_b128 v[204:207], v10 offset:5120
    buffer_load_dwordx4 v3, s[28:31], s44 offen offset:2048 sc1 lds
    v_mfma_f32_32x32x16_bf16 v[32:47], v[120:123], v[212:215], v[32:47]
    s_waitcnt vmcnt(13)
    ds_read_b64_tr_b16 v[132:133], v6 offset:1024
    ds_read_b64_tr_b16 v[134:135], v6 offset:1536
    v_dot2c_f32_bf16 v12, v92, v92
    v_dot2c_f32_bf16 v13, v93, v93
    v_dot2c_f32_bf16 v12, v94, v94
    v_dot2c_f32_bf16 v13, v95, v95
    v_dot2c_f32_bf16 v12, v96, v96
    v_dot2c_f32_bf16 v13, v97, v97
    v_dot2c_f32_bf16 v12, v98, v98
    v_dot2c_f32_bf16 v13, v99, v99
    v_dot2c_f32_bf16 v12, v100, v100
    v_dot2c_f32_bf16 v13, v101, v101
    v_dot2c_f32_bf16 v12, v102, v102
    v_dot2c_f32_bf16 v13, v103, v103
    v_dot2c_f32_bf16 v12, v104, v104
    v_dot2c_f32_bf16 v13, v105, v105
    v_dot2c_f32_bf16 v12, v106, v106
    v_dot2c_f32_bf16 v13, v107, v107
    v_dot2c_f32_bf16 v12, v108, v108
    v_dot2c_f32_bf16 v13, v109, v109
    v_dot2c_f32_bf16 v12, v110, v110
    v_dot2c_f32_bf16 v13, v111, v111
    v_dot2c_f32_bf16 v12, v112, v112
    v_dot2c_f32_bf16 v13, v113, v113
    v_dot2c_f32_bf16 v12, v114, v114
    v_dot2c_f32_bf16 v13, v115, v115
    v_dot2c_f32_bf16 v12, v116, v116
    v_dot2c_f32_bf16 v13, v117, v117
    v_dot2c_f32_bf16 v12, v118, v118
    v_dot2c_f32_bf16 v13, v119, v119
    v_dot2c_f32_bf16 v12, v120, v120
    v_dot2c_f32_bf16 v13, v121, v121
    v_dot2c_f32_bf16 v12, v122, v122
    v_dot2c_f32_bf16 v13, v123, v123
    s_waitcnt lgkmcnt(8)
    v_mfma_f32_32x32x16_bf16 v[16:31], v[216:219], v[124:127], v[16:31]
    ds_read_b128 v[208:211], v10 offset:7168
    ds_read_b128 v[212:215], v10 offset:8192
    buffer_load_dwordx4 v3, s[28:31], s44 offen offset:3072 sc1 lds
    v_mfma_f32_32x32x16_bf16 v[32:47], v[124:127], v[220:223], v[32:47]
    s_waitcnt vmcnt(13)
    ds_read_b64_tr_b16 v[136:137], v6 offset:2048
    ds_read_b64_tr_b16 v[138:139], v6 offset:2560
    s_waitcnt lgkmcnt(8)
    v_mfma_f32_32x32x16_bf16 v[16:31], v[192:195], v[128:131], v[16:31]
    ds_read_b128 v[216:219], v10 offset:10240
    ds_read_b128 v[220:223], v10 offset:11264
    buffer_load_dwordx4 v[224:227], v4, s[28:31], s40 offen offset:2048 sc1
    buffer_load_dwordx4 v[228:231], v4, s[28:31], s40 offen offset:2080 sc1
    buffer_load_dwordx4 v[232:235], v4, s[28:31], s40 offen offset:2112 sc1
    buffer_load_dwordx4 v[236:239], v4, s[28:31], s40 offen offset:2144 sc1
    buffer_load_dword v14, v5, s[28:31], s40 offen sc1
    s_cmp_lg_u32 s46, 0
    s_cbranch_scc1 mg_nb38
    s_barrier
mg_nb38:
    v_mfma_f32_32x32x16_bf16 v[32:47], v[128:131], v[196:199], v[32:47]
    s_waitcnt vmcnt(17)
    ds_read_b64_tr_b16 v[140:141], v6 offset:3072
    ds_read_b64_tr_b16 v[142:143], v6 offset:3584
    s_waitcnt lgkmcnt(8)
    v_mfma_f32_32x32x16_bf16 v[16:31], v[200:203], v[132:135], v[16:31]
    s_add_u32 s45, s35, 5
    s_and_b32 s45, s45, 7
    s_mul_i32 s45, s45, 12288
    s_add_u32 s45, s45, 65536
    v_add_u32 v11, s45, v3
    ds_read_b128 v[192:195], v11 offset:1024
    ds_read_b128 v[196:199], v11 offset:2048
    v_mfma_f32_32x32x16_bf16 v[32:47], v[132:135], v[204:207], v[32:47]
    s_waitcnt vmcnt(16)
    ds_read_b64_tr_b16 v[144:145], v6 offset:4096
    ds_read_b64_tr_b16 v[146:147], v6 offset:4608
    s_waitcnt lgkmcnt(8)
    v_mfma_f32_32x32x16_bf16 v[16:31], v[208:211], v[136:139], v[16:31]
    ds_read_b128 v[200:203], v11 offset:4096
    ds_read_b128 v[204:207], v11 offset:5120
    v_mfma_f32_32x32x16_bf16 v[32:47], v[136:139], v[212:215], v[32:47]
    s_waitcnt vmcnt(15)
    ds_read_b64_tr_b16 v[148:149], v6 offset:5120
    ds_read_b64_tr_b16 v[150:151], v6 offset:5632
    s_waitcnt lgkmcnt(8)
    v_mfma_f32_32x32x16_bf16 v[16:31], v[216:219], v[140:143], v[16:31]
    ds_read_b128 v[208:211], v11 offset:7168
    ds_read_b128 v[212:215], v11 offset:8192
    v_mfma_f32_32x32x16_bf16 v[32:47], v[140:143], v[220:223], v[32:47]
    s_waitcnt vmcnt(14)
    ds_read_b64_tr_b16 v[152:153], v6 offset:6144
    ds_read_b64_tr_b16 v[154:155], v6 offset:6656
    s_waitcnt lgkmcnt(8)
    v_mfma_f32_32x32x16_bf16 v[16:31], v[192:195], v[144:147], v[16:31]
    ds_read_b128 v[216:219], v11 offset:10240
    ds_read_b128 v[220:223], v11 offset:11264
    v_mfma_f32_32x32x16_bf16 v[32:47], v[144:147], v[196:199], v[32:47]
    s_waitcnt vmcnt(13)
    ds_read_b64_tr_b16 v[156:157], v6 offset:7168
    ds_read_b64_tr_b16 v[158:159], v6 offset:7680
    s_waitcnt lgkmcnt(8)
    v_mfma_f32_32x32x16_bf16 v[16:31], v[200:203], v[148:151], v[16:31]
    s_add_u32 s45, s35, 6
    s_and_b32 s45, s45, 7
    s_mul_i32 s45, s45, 12288
    s_add_u32 s45, s45, 65536
    v_add_u32 v10, s45, v3
    ds_read_b128 v[192:195], v10 offset:1024
    ds_read_b128 v[196:199], v10 offset:2048
    v_mfma_f32_32x32x16_bf16 v[32:47], v[148:151], v[204:207], v[32:47]
    s_waitcnt vmcnt(12)
    ds_read_b64_tr_b16 v[160:161], v6 offset:8192
    ds_read_b64_tr_b16 v[162:163], v6 offset:8704
    s_waitcnt lgkmcnt(8)
    v_mfma_f32_32x32x16_bf16 v[16:31], v[208:211], v[152:155], v[16:31]
    ds_read_b128 v[200:203], v10 offset:4096
    ds_read_b128 v[204:207], v10 offset:5120
    v_mfma_f32_32x32x16_bf16 v[32:47], v[152:155], v[212:215], v[32:47]
    s_waitcnt vmcnt(11)
    ds_read_b64_tr_b16 v[164:165], v6 offset:9216
    ds_read_b64_tr_b16 v[166:167], v6 offset:9728
    v_dot2c_f32_bf16 v12, v124, v124
    v_dot2c_f32_bf16 v13, v125, v125
    v_dot2c_f32_bf16 v12, v126, v126
    v_dot2c_f32_bf16 v13, v127, v127
    v_dot2c_f32_bf16 v12, v128, v128
    v_dot2c_f32_bf16 v13, v129, v129
    v_dot2c_f32_bf16 v12, v130, v130
    v_dot2c_f32_bf16 v13, v131, v131
    v_dot2c_f32_bf16 v12, v132, v132
    v_dot2c_f32_bf16 v13, v133, v133
    v_dot2c_f32_bf16 v12, v134, v134
    v_dot2c_f32_bf16 v13, v135, v135
    v_dot2c_f32_bf16 v12, v136, v136
    v_dot2c_f32_bf16 v13, v137, v137
    v_dot2c_f32_bf16 v12, v138, v138
    v_dot2c_f32_bf16 v13, v139, v139
    v_dot2c_f32_bf16 v12, v140, v140
    v_dot2c_f32_bf16 v13, v141, v141
    v_dot2c_f32_bf16 v12, v142, v142
    v_dot2c_f32_bf16 v13, v143, v143
    v_dot2c_f32_bf16 v12, v144, v144
    v_dot2c_f32_bf16 v13, v145, v145
    v_dot2c_f32_bf16 v12, v146, v146
    v_dot2c_f32_bf16 v13, v147, v147
    v_dot2c_f32_bf16 v12, v148, v148
    v_dot2c_f32_bf16 v13, v149, v149
    v_dot2c_f32_bf16 v12, v150, v150
    v_dot2c_f32_bf16 v13, v151, v151
    v_dot2c_f32_bf16 v12, v152, v152
    v_dot2c_f32_bf16 v13, v153, v153
    v_dot2c_f32_bf16 v12, v154, v154
    v_dot2c_f32_bf16 v13, v155, v155
    s_waitcnt lgkmcnt(8)
    v_mfma_f32_32x32x16_bf16 v[16:31], v[216:219], v[156:159], v[16:31]
    ds_read_b128 v[208:211], v10 offset:7168
    ds_read_b128 v[212:215], v10 offset:8192
    v_mfma_f32_32x32x16_bf16 v[32:47], v[156:159], v[220:223], v[32:47]
    s_waitcnt vmcnt(10)
    ds_read_b64_tr_b16 v[168:169], v6 offset:10240
    ds_read_b64_tr_b16 v[170:171], v6 offset:10752
    s_waitcnt lgkmcnt(8)
    v_mfma_f32_32x32x16_bf16 v[16:31], v[192:195], v[160:163], v[16:31]
    ds_read_b128 v[216:219], v10 offset:10240
    ds_read_b128 v[220:223], v10 offset:11264
    v_mfma_f32_32x32x16_bf16 v[32:47], v[160:163], v[196:199], v[32:47]
    s_waitcnt vmcnt(9)
    ds_read_b64_tr_b16 v[172:173], v6 offset:11264
    ds_read_b64_tr_b16 v[174:175], v6 offset:11776
    s_waitcnt lgkmcnt(8)
    v_mfma_f32_32x32x16_bf16 v[16:31], v[200:203], v[164:167], v[16:31]
    s_add_u32 s45, s35, 7
    s_and_b32 s45, s45, 7
    s_mul_i32 s45, s45, 12288
    s_add_u32 s45, s45, 65536
    v_add_u32 v11, s45, v3
    ds_read_b128 v[192:195], v11 offset:1024
    ds_read_b128 v[196:199], v11 offset:2048
    v_mfma_f32_32x32x16_bf16 v[32:47], v[164:167], v[204:207], v[32:47]
    s_waitcnt vmcnt(8)
    ds_read_b64_tr_b16 v[176:177], v6 offset:12288
    ds_read_b64_tr_b16 v[178:179], v6 offset:12800
    s_waitcnt lgkmcnt(8)
    v_mfma_f32_32x32x16_bf16 v[16:31], v[208:211], v[168:171], v[16:31]
    ds_read_b128 v[200:203], v11 offset:4096
    ds_read_b128 v[204:207], v11 offset:5120
    v_mfma_f32_32x32x16_bf16 v[32:47], v[168:171], v[212:215], v[32:47]
    s_waitcnt vmcnt(7)
    ds_read_b64_tr_b16 v[180:181], v6 offset:13312
    ds_read_b64_tr_b16 v[182:183], v6 offset:13824
    s_waitcnt lgkmcnt(8)
    v_mfma_f32_32x32x16_bf16 v[16:31], v[216:219], v[172:175], v[16:31]
    ds_read_b128 v[208:211], v11 offset:7168
    ds_read_b128 v[212:215], v11 offset:8192
    v_mfma_f32_32x32x16_bf16 v[32:47], v[172:175], v[220:223], v[32:47]
    s_waitcnt vmcnt(6)
    ds_read_b64_tr_b16 v[184:185], v6 offset:14336
    ds_read_b64_tr_b16 v[186:187], v6 offset:14848
    s_waitcnt lgkmcnt(8)
    v_mfma_f32_32x32x16_bf16 v[16:31], v[192:195], v[176:179], v[16:31]
    ds_read_b128 v[216:219], v11 offset:10240
    ds_read_b128 v[220:223], v11 offset:11264
    v_mfma_f32_32x32x16_bf16 v[32:47], v[176:179], v[196:199], v[32:47]
    s_waitcnt vmcnt(5)
    ds_read_b64_tr_b16 v[188:189], v6 offset:15360
    ds_read_b64_tr_b16 v[190:191], v6 offset:15872
    s_waitcnt lgkmcnt(8)
    v_mfma_f32_32x32x16_bf16 v[16:31], v[200:203], v[180:183], v[16:31]
    v_mfma_f32_32x32x16_bf16 v[32:47], v[180:183], v[204:207], v[32:47]
    s_waitcnt lgkmcnt(4)
    v_mfma_f32_32x32x16_bf16 v[16:31], v[208:211], v[184:187], v[16:31]
    v_mfma_f32_32x32x16_bf16 v[32:47], v[184:187], v[212:215], v[32:47]
    v_dot2c_f32_bf16 v12, v156, v156
    v_dot2c_f32_bf16 v13, v157, v157
    v_dot2c_f32_bf16 v12, v158, v158
    v_dot2c_f32_bf16 v13, v159, v159
    v_dot2c_f32_bf16 v12, v160, v160
    v_dot2c_f32_bf16 v13, v161, v161
    v_dot2c_f32_bf16 v12, v162, v162
    v_dot2c_f32_bf16 v13, v163, v163
    v_dot2c_f32_bf16 v12, v164, v164
    v_dot2c_f32_bf16 v13, v165, v165
    v_dot2c_f32_bf16 v12, v166, v166
    v_dot2c_f32_bf16 v13, v167, v167
    v_dot2c_f32_bf16 v12, v168, v168
    v_dot2c_f32_bf16 v13, v169, v169
    v_dot2c_f32_bf16 v12, v170, v170
    v_dot2c_f32_bf16 v13, v171, v171
    v_dot2c_f32_bf16 v12, v172, v172
    v_dot2c_f32_bf16 v13, v173, v173
    v_dot2c_f32_bf16 v12, v174, v174
    v_dot2c_f32_bf16 v13, v175, v175
    v_dot2c_f32_bf16 v12, v176, v176
    v_dot2c_f32_bf16 v13, v177, v177
    v_dot2c_f32_bf16 v12, v178, v178
    v_dot2c_f32_bf16 v13, v179, v179
    v_dot2c_f32_bf16 v12, v180, v180
    v_dot2c_f32_bf16 v13, v181, v181
    v_dot2c_f32_bf16 v12, v182, v182
    v_dot2c_f32_bf16 v13, v183, v183
    v_dot2c_f32_bf16 v12, v184, v184
    v_dot2c_f32_bf16 v13, v185, v185
    v_dot2c_f32_bf16 v12, v186, v186
    v_dot2c_f32_bf16 v13, v187, v187
    s_waitcnt lgkmcnt(1)
    v_dot2c_f32_bf16 v12, v188, v188
    v_dot2c_f32_bf16 v13, v189, v189
    s_waitcnt lgkmcnt(0)
    v_dot2c_f32_bf16 v12, v190, v190
    v_dot2c_f32_bf16 v13, v191, v191
    v_mfma_f32_32x32x16_bf16 v[16:31], v[216:219], v[188:191], v[16:31]
    v_mfma_f32_32x32x16_bf16 v[32:47], v[188:191], v[220:223], v[32:47]
    s_nop 0
    v_cmp_u_f32 vcc, v12, v13
    s_cbranch_vccz mg_go39
    s_add_u32 s46, s46, 1
    s_cmp_gt_u32 s46, 64
    s_cbranch_scc1 mg_go39
    v_mov_b32 v12, 0
    v_mov_b32 v13, 0
    s_branch mg_rs37
mg_go39:
    v_add_f32 v12, v12, v13
    s_mov_b32 s4, 0x3b000000
    v_mov_b32 v15, 0x3727c5ac
    v_mov_b32 v13, v12
    s_add_u32 s5, s42, 6144
    v_lshl_add_u32 v10, v8, 2, s5
    v_permlane32_swap_b32 v12, v13
    v_lshl_add_u32 v11, v9, 4, s5
    v_add_f32 v12, v12, v13
    v_fma_f32 v12, s4, v12, v15
    v_add_u32 v5, s42, v3
    v_mov_b32 v240, v31
    v_mov_b32 v241, v31
    s_waitcnt vmcnt(0)
    s_nop 0
    v_permlane32_swap_b32 v240, v241
    v_mul_f32 v240, s4, v240
    v_fma_f32 v12, -v240, v240, v12
    v_max_f32 v12, v12, v15
    v_rsq_f32 v12, v12
    s_nop 0
    v_mul_f32 v13, v12, v240
    ds_write2_b32 v10, v12, v13 offset0:0 offset1:32
    v_mul_f32 v12, 1069066811, v12
    ds_read_b128 v[192:195], v11 offset:0
    v_pk_fma_f32 v[16:17], v[224:225], v[240:241], v[16:17] op_sel:[0,0,0] op_sel_hi:[1,0,1] neg_lo:[0,1,0] neg_hi:[0,1,0]
    ds_read_b128 v[196:199], v11 offset:32
    v_pk_fma_f32 v[18:19], v[226:227], v[240:241], v[18:19] op_sel:[0,0,0] op_sel_hi:[1,0,1] neg_lo:[0,1,0] neg_hi:[0,1,0]
    ds_read_b128 v[200:203], v11 offset:64
    v_pk_fma_f32 v[20:21], v[228:229], v[240:241], v[20:21] op_sel:[0,0,0] op_sel_hi:[1,0,1] neg_lo:[0,1,0] neg_hi:[0,1,0]
    ds_read_b128 v[204:207], v11 offset:96
    v_pk_fma_f32 v[22:23], v[230:231], v[240:241], v[22:23] op_sel:[0,0,0] op_sel_hi:[1,0,1] neg_lo:[0,1,0] neg_hi:[0,1,0]
    ds_read_b128 v[208:211], v11 offset:128
    v_pk_fma_f32 v[24:25], v[232:233], v[240:241], v[24:25] op_sel:[0,0,0] op_sel_hi:[1,0,1] neg_lo:[0,1,0] neg_hi:[0,1,0]
    ds_read_b128 v[212:215], v11 offset:160
    v_pk_fma_f32 v[26:27], v[234:235], v[240:241], v[26:27] op_sel:[0,0,0] op_sel_hi:[1,0,1] neg_lo:[0,1,0] neg_hi:[0,1,0]
    ds_read_b128 v[216:219], v11 offset:192
    v_pk_fma_f32 v[28:29], v[236:237], v[240:241], v[28:29] op_sel:[0,0,0] op_sel_hi:[1,0,1] neg_lo:[0,1,0] neg_hi:[0,1,0]
    ds_read_b128 v[220:223], v11 offset:224
    v_pk_fma_f32 v[30:31], v[238:239], v[240:241], v[30:31] op_sel:[0,0,0] op_sel_hi:[1,0,1] neg_lo:[0,1,0] neg_hi:[0,1,0]
    s_mov_b32 exec_hi, 0
    v_mov_b32 v31, 0
    s_mov_b64 exec, -1
    v_max3_f32 v48, v16, v17, v18
    v_min3_f32 v56, v16, v17, v18
    v_max3_f32 v49, v19, v20, v21
    v_min3_f32 v57, v19, v20, v21
    v_max3_f32 v50, v22, v23, v24
    v_min3_f32 v58, v22, v23, v24
    v_max3_f32 v51, v25, v26, v27
    v_min3_f32 v59, v25, v26, v27
    v_max3_f32 v52, v28, v29, v30
    v_min3_f32 v60, v28, v29, v30
    v_max3_f32 v48, v48, v49, v50
    v_min3_f32 v56, v56, v57, v58
    v_max3_f32 v51, v51, v52, v31
    v_min3_f32 v59, v59, v60, v31
    v_max_f32 v224, v48, v51
    v_min_f32 v226, v56, v59
    v_mul_f32 v224, v224, v12
    v_mul_f32 v226, v226, v12
    v_pk_fma_f32 v[48:49], v[16:17], v[12:13], v[226:227] op_sel:[0,0,0] op_sel_hi:[1,0,0] neg_lo:[1,0,0] neg_hi:[1,0,0]
    v_pk_fma_f32 v[50:51], v[18:19], v[12:13], v[226:227] op_sel:[0,0,0] op_sel_hi:[1,0,0] neg_lo:[1,0,0] neg_hi:[1,0,0]
    v_pk_fma_f32 v[52:53], v[20:21], v[12:13], v[226:227] op_sel:[0,0,0] op_sel_hi:[1,0,0] neg_lo:[1,0,0] neg_hi:[1,0,0]
    v_pk_fma_f32 v[54:55], v[22:23], v[12:13], v[226:227] op_sel:[0,0,0] op_sel_hi:[1,0,0] neg_lo:[1,0,0] neg_hi:[1,0,0]
    v_pk_fma_f32 v[56:57], v[24:25], v[12:13], v[226:227] op_sel:[0,0,0] op_sel_hi:[1,0,0] neg_lo:[1,0,0] neg_hi:[1,0,0]
    v_pk_fma_f32 v[58:59], v[26:27], v[12:13], v[226:227] op_sel:[0,0,0] op_sel_hi:[1,0,0] neg_lo:[1,0,0] neg_hi:[1,0,0]
    v_pk_fma_f32 v[60:61], v[28:29], v[12:13], v[226:227] op_sel:[0,0,0] op_sel_hi:[1,0,0] neg_lo:[1,0,0] neg_hi:[1,0,0]
    v_pk_fma_f32 v[62:63], v[30:31], v[12:13], v[226:227] op_sel:[0,0,0] op_sel_hi:[1,0,0] neg_lo:[1,0,0] neg_hi:[1,0,0]
    v_pk_fma_f32 v[16:17], v[16:17], v[12:13], v[224:225] op_sel:[0,0,0] op_sel_hi:[1,0,0] neg_lo:[0,0,1] neg_hi:[0,0,1]
    v_pk_fma_f32 v[18:19], v[18:19], v[12:13], v[224:225] op_sel:[0,0,0] op_sel_hi:[1,0,0] neg_lo:[0,0,1] neg_hi:[0,0,1]
    v_pk_fma_f32 v[20:21], v[20:21], v[12:13], v[224:225] op_sel:[0,0,0] op_sel_hi:[1,0,0] neg_lo:[0,0,1] neg_hi:[0,0,1]
    v_pk_fma_f32 v[22:23], v[22:23], v[12:13], v[224:225] op_sel:[0,0,0] op_sel_hi:[1,0,0] neg_lo:[0,0,1] neg_hi:[0,0,1]
    v_pk_fma_f32 v[24:25], v[24:25], v[12:13], v[224:225] op_sel:[0,0,0] op_sel_hi:[1,0,0] neg_lo:[0,0,1] neg_hi:[0,0,1]
    v_pk_fma_f32 v[26:27], v[26:27], v[12:13], v[224:225] op_sel:[0,0,0] op_sel_hi:[1,0,0] neg_lo:[0,0,1] neg_hi:[0,0,1]
    v_pk_fma_f32 v[28:29], v[28:29], v[12:13], v[224:225] op_sel:[0,0,0] op_sel_hi:[1,0,0] neg_lo:[0,0,1] neg_hi:[0,0,1]
    v_pk_fma_f32 v[30:31], v[30:31], v[12:13], v[224:225] op_sel:[0,0,0] op_sel_hi:[1,0,0] neg_lo:[0,0,1] neg_hi:[0,0,1]
    s_waitcnt lgkmcnt(0)
    v_pk_mul_f32 v[32:33], v[32:33], v[192:193]
    v_pk_mul_f32 v[34:35], v[34:35], v[194:195]
    v_pk_mul_f32 v[36:37], v[36:37], v[196:197]
    v_pk_mul_f32 v[38:39], v[38:39], v[198:199]
    v_pk_mul_f32 v[40:41], v[40:41], v[200:201]
    v_pk_mul_f32 v[42:43], v[42:43], v[202:203]
    v_pk_mul_f32 v[44:45], v[44:45], v[204:205]
    v_pk_mul_f32 v[46:47], v[46:47], v[206:207]
    v_pk_fma_f32 v[32:33], v[208:209], v[14:15], v[32:33] op_sel:[0,0,0] op_sel_hi:[1,0,1] neg_lo:[0,1,0] neg_hi:[0,1,0]
    v_pk_fma_f32 v[34:35], v[210:211], v[14:15], v[34:35] op_sel:[0,0,0] op_sel_hi:[1,0,1] neg_lo:[0,1,0] neg_hi:[0,1,0]
    v_pk_fma_f32 v[36:37], v[212:213], v[14:15], v[36:37] op_sel:[0,0,0] op_sel_hi:[1,0,1] neg_lo:[0,1,0] neg_hi:[0,1,0]
    v_pk_fma_f32 v[38:39], v[214:215], v[14:15], v[38:39] op_sel:[0,0,0] op_sel_hi:[1,0,1] neg_lo:[0,1,0] neg_hi:[0,1,0]
    v_pk_fma_f32 v[40:41], v[216:217], v[14:15], v[40:41] op_sel:[0,0,0] op_sel_hi:[1,0,1] neg_lo:[0,1,0] neg_hi:[0,1,0]
    v_pk_fma_f32 v[42:43], v[218:219], v[14:15], v[42:43] op_sel:[0,0,0] op_sel_hi:[1,0,1] neg_lo:[0,1,0] neg_hi:[0,1,0]
    v_pk_fma_f32 v[44:45], v[220:221], v[14:15], v[44:45] op_sel:[0,0,0] op_sel_hi:[1,0,1] neg_lo:[0,1,0] neg_hi:[0,1,0]
    v_pk_fma_f32 v[46:47], v[222:223], v[14:15], v[46:47] op_sel:[0,0,0] op_sel_hi:[1,0,1] neg_lo:[0,1,0] neg_hi:[0,1,0]
    s_barrier
    s_add_u32 s45, s35, 0
    s_and_b32 s45, s45, 7
    s_mul_i32 s45, s45, 12288
    s_add_u32 s45, s45, 65536
    v_add_u32 v10, s45, v3
    ds_read_b128 v[192:195], v10 offset:0
    v_cvt_pk_bf16_f32 v32, v32, v33
    v_cvt_pk_bf16_f32 v33, v34, v35
    ds_read_b128 v[196:199], v10 offset:3072
    v_cvt_pk_bf16_f32 v34, v36, v37
    v_cvt_pk_bf16_f32 v35, v38, v39
    ds_read_b128 v[200:203], v10 offset:6144
    v_cvt_pk_bf16_f32 v36, v40, v41
    v_cvt_pk_bf16_f32 v37, v42, v43
    ds_read_b128 v[204:207], v10 offset:9216
    v_cvt_pk_bf16_f32 v38, v44, v45
    v_cvt_pk_bf16_f32 v39, v46, v47
    ds_write_b128 v5, v[32:35] offset:4096
    ds_write_b128 v5, v[36:39] offset:5120
    v_exp_f32 v48, v48
    v_exp_f32 v49, v49
    s_waitcnt lgkmcnt(5)
    v_mfma_f32_32x32x16_bf16 v[32:47], v[192:195], v[64:67], 0
    s_add_u32 s45, s35, 1
    s_and_b32 s45, s45, 7
    s_mul_i32 s45, s45, 12288
    s_add_u32 s45, s45, 65536
    v_add_u32 v11, s45, v3
    ds_read_b128 v[208:211], v11 offset:0
    v_exp_f32 v50, v50
    v_exp_f32 v51, v51
    v_exp_f32 v52, v52
    s_waitcnt lgkmcnt(5)
    v_mfma_f32_32x32x16_bf16 v[32:47], v[196:199], v[68:71], v[32:47]
    ds_read_b128 v[212:215], v11 offset:3072
    v_exp_f32 v53, v53
    v_exp_f32 v54, v54
    v_exp_f32 v55, v55
    s_waitcnt lgkmcnt(5)
    v_mfma_f32_32x32x16_bf16 v[32:47], v[200:203], v[72:75], v[32:47]
    ds_read_b128 v[216:219], v11 offset:6144
    v_exp_f32 v56, v56
    v_exp_f32 v57, v57
    v_exp_f32 v58, v58
    s_waitcnt lgkmcnt(5)
    v_mfma_f32_32x32x16_bf16 v[32:47], v[204:207], v[76:79], v[32:47]
    ds_read_b128 v[220:223], v11 offset:9216
    v_exp_f32 v59, v59
    v_exp_f32 v60, v60
    v_exp_f32 v61, v61
    s_waitcnt lgkmcnt(3)
    v_mfma_f32_32x32x16_bf16 v[32:47], v[208:211], v[80:83], v[32:47]
    s_add_u32 s45, s35, 2
    s_and_b32 s45, s45, 7
    s_mul_i32 s45, s45, 12288
    s_add_u32 s45, s45, 65536
    v_add_u32 v10, s45, v3
    ds_read_b128 v[192:195], v10 offset:0
    v_exp_f32 v62, v62
    v_exp_f32 v63, v63
    v_exp_f32 v16, v16
    s_waitcnt lgkmcnt(3)
    v_mfma_f32_32x32x16_bf16 v[32:47], v[212:215], v[84:87], v[32:47]
    ds_read_b128 v[196:199], v10 offset:3072
    v_exp_f32 v17, v17
    v_exp_f32 v18, v18
    v_exp_f32 v19, v19
    s_waitcnt lgkmcnt(3)
    v_mfma_f32_32x32x16_bf16 v[32:47], v[216:219], v[88:91], v[32:47]
    ds_read_b128 v[200:203], v10 offset:6144
    v_exp_f32 v20, v20
    v_exp_f32 v21, v21
    v_exp_f32 v22, v22
    s_waitcnt lgkmcnt(3)
    v_mfma_f32_32x32x16_bf16 v[32:47], v[220:223], v[92:95], v[32:47]
    ds_read_b128 v[204:207], v10 offset:9216
    v_exp_f32 v23, v23
    v_exp_f32 v24, v24
    v_exp_f32 v25, v25
    s_waitcnt lgkmcnt(3)
    v_mfma_f32_32x32x16_bf16 v[32:47], v[192:195], v[96:99], v[32:47]
    s_add_u32 s45, s35, 3
    s_and_b32 s45, s45, 7
    s_mul_i32 s45, s45, 12288
    s_add_u32 s45, s45, 65536
    v_add_u32 v11, s45, v3
    ds_read_b128 v[208:211], v11 offset:0
    v_exp_f32 v26, v26
    v_exp_f32 v27, v27
    v_exp_f32 v28, v28
    v_exp_f32 v29, v29
    v_exp_f32 v30, v30
    v_exp_f32 v31, v31
    v_pk_add_f32 v[232:233], v[48:49], v[50:51]
    v_pk_add_f32 v[234:235], v[52:53], v[54:55]
    v_pk_add_f32 v[228:229], v[16:17], v[18:19]
    v_pk_add_f32 v[230:231], v[20:21], v[22:23]
    v_pk_add_f32 v[232:233], v[232:233], v[56:57]
    v_pk_add_f32 v[234:235], v[234:235], v[58:59]
    v_pk_add_f32 v[228:229], v[228:229], v[24:25]
    v_pk_add_f32 v[230:231], v[230:231], v[26:27]
    v_pk_add_f32 v[232:233], v[232:233], v[60:61]
    v_pk_add_f32 v[234:235], v[234:235], v[62:63]
    v_pk_add_f32 v[228:229], v[228:229], v[28:29]
    v_pk_add_f32 v[230:231], v[230:231], v[30:31]
    v_pk_add_f32 v[226:227], v[232:233], v[234:235]
    v_pk_add_f32 v[224:225], v[228:229], v[230:231]
    v_add_f32 v226, v226, v227
    v_add_f32 v224, v224, v225
    v_rcp_f32 v226, v226
    v_rcp_f32 v224, v224
    v_pk_mul_f32 v[48:49], v[48:49], v[226:227] op_sel:[0,0] op_sel_hi:[1,0]
    v_pk_mul_f32 v[50:51], v[50:51], v[226:227] op_sel:[0,0] op_sel_hi:[1,0]
    v_pk_mul_f32 v[52:53], v[52:53], v[226:227] op_sel:[0,0] op_sel_hi:[1,0]
    v_pk_mul_f32 v[54:55], v[54:55], v[226:227] op_sel:[0,0] op_sel_hi:[1,0]
    v_pk_mul_f32 v[56:57], v[56:57], v[226:227] op_sel:[0,0] op_sel_hi:[1,0]
    v_pk_mul_f32 v[58:59], v[58:59], v[226:227] op_sel:[0,0] op_sel_hi:[1,0]
    v_pk_mul_f32 v[60:61], v[60:61], v[226:227] op_sel:[0,0] op_sel_hi:[1,0]
    v_pk_mul_f32 v[62:63], v[62:63], v[226:227] op_sel:[0,0] op_sel_hi:[1,0]
    v_pk_mul_f32 v[16:17], v[16:17], v[224:225] op_sel:[0,0] op_sel_hi:[1,0]
    v_pk_mul_f32 v[18:19], v[18:19], v[224:225] op_sel:[0,0] op_sel_hi:[1,0]
    v_pk_mul_f32 v[20:21], v[20:21], v[224:225] op_sel:[0,0] op_sel_hi:[1,0]
    v_pk_mul_f32 v[22:23], v[22:23], v[224:225] op_sel:[0,0] op_sel_hi:[1,0]
    v_pk_mul_f32 v[24:25], v[24:25], v[224:225] op_sel:[0,0] op_sel_hi:[1,0]
    v_pk_mul_f32 v[26:27], v[26:27], v[224:225] op_sel:[0,0] op_sel_hi:[1,0]
    v_pk_mul_f32 v[28:29], v[28:29], v[224:225] op_sel:[0,0] op_sel_hi:[1,0]
    v_pk_mul_f32 v[30:31], v[30:31], v[224:225] op_sel:[0,0] op_sel_hi:[1,0]
    s_waitcnt lgkmcnt(3)
    v_mfma_f32_32x32x16_bf16 v[32:47], v[196:199], v[100:103], v[32:47]
    ds_read_b128 v[212:215], v11 offset:3072
    v_cvt_pk_bf16_f32 v48, v48, v49
    v_cvt_pk_bf16_f32 v49, v50, v51
    v_cvt_pk_bf16_f32 v50, v52, v53
    v_cvt_pk_bf16_f32 v51, v54, v55
    v_cvt_pk_bf16_f32 v52, v56, v57
    s_waitcnt lgkmcnt(3)
    v_mfma_f32_32x32x16_bf16 v[32:47], v[200:203], v[104:107], v[32:47]
    ds_read_b128 v[216:219], v11 offset:6144
    v_cvt_pk_bf16_f32 v53, v58, v59
    v_cvt_pk_bf16_f32 v54, v60, v61
    v_cvt_pk_bf16_f32 v55, v62, v63
    s_waitcnt lgkmcnt(3)
    v_mfma_f32_32x32x16_bf16 v[32:47], v[204:207], v[108:111], v[32:47]
    ds_read_b128 v[220:223], v11 offset:9216
    v_cvt_pk_bf16_f32 v16, v16, v17
    v_cvt_pk_bf16_f32 v17, v18, v19
    v_cvt_pk_bf16_f32 v18, v20, v21
    v_cvt_pk_bf16_f32 v19, v22, v23
    v_cvt_pk_bf16_f32 v20, v24, v25
    s_waitcnt lgkmcnt(3)
    v_mfma_f32_32x32x16_bf16 v[32:47], v[208:211], v[112:115], v[32:47]
    s_add_u32 s45, s35, 4
    s_and_b32 s45, s45, 7
    s_mul_i32 s45, s45, 12288
    s_add_u32 s45, s45, 65536
    v_add_u32 v10, s45, v3
    ds_read_b128 v[192:195], v10 offset:0
    v_cvt_pk_bf16_f32 v21, v26, v27
    v_cvt_pk_bf16_f32 v22, v28, v29
    v_cvt_pk_bf16_f32 v23, v30, v31
    v_xor_b32 v13, 32, v7
    ds_write_b128 v13, v[48:51] offset:0
    s_waitcnt lgkmcnt(4)
    v_mfma_f32_32x32x16_bf16 v[32:47], v[212:215], v[116:119], v[32:47]
    ds_read_b128 v[196:199], v10 offset:3072
    v_xor_b32 v13, 48, v7
    ds_write_b128 v13, v[52:55] offset:0
    s_waitcnt lgkmcnt(5)
    v_mfma_f32_32x32x16_bf16 v[32:47], v[216:219], v[120:123], v[32:47]
    ds_read_b128 v[200:203], v10 offset:6144
    ds_write_b128 v7, v[16:19] offset:0
    s_waitcnt lgkmcnt(6)
    v_mfma_f32_32x32x16_bf16 v[32:47], v[220:223], v[124:127], v[32:47]
    ds_read_b128 v[204:207], v10 offset:9216
    v_xor_b32 v13, 16, v7
    ds_write_b128 v13, v[20:23] offset:0
    s_waitcnt lgkmcnt(0)
    s_barrier
    buffer_load_dwordx4 v[16:19], v4, s[28:31], s40 offen offset:0 sc1
    buffer_load_dwordx4 v[20:23], v4, s[28:31], s40 offen offset:32 sc1
    buffer_load_dwordx4 v[24:27], v4, s[28:31], s40 offen offset:64 sc1
    buffer_load_dwordx4 v[28:31], v4, s[28:31], s40 offen offset:96 sc1
    v_mfma_f32_32x32x16_bf16 v[32:47], v[192:195], v[128:131], v[32:47]
    s_add_u32 s45, s35, 5
    s_and_b32 s45, s45, 7
    s_mul_i32 s45, s45, 12288
    s_add_u32 s45, s45, 65536
    v_add_u32 v11, s45, v3
    ds_read_b128 v[208:211], v11 offset:0
    v_mfma_f32_32x32x16_bf16 v[32:47], v[196:199], v[132:135], v[32:47]
    ds_read_b128 v[212:215], v11 offset:3072
    v_mfma_f32_32x32x16_bf16 v[32:47], v[200:203], v[136:139], v[32:47]
    ds_read_b128 v[216:219], v11 offset:6144
    v_mfma_f32_32x32x16_bf16 v[32:47], v[204:207], v[140:143], v[32:47]
    ds_read_b128 v[220:223], v11 offset:9216
    s_waitcnt lgkmcnt(3)
    v_mfma_f32_32x32x16_bf16 v[32:47], v[208:211], v[144:147], v[32:47]
    s_add_u32 s45, s35, 6
    s_and_b32 s45, s45, 7
    s_mul_i32 s45, s45, 12288
    s_add_u32 s45, s45, 65536
    v_add_u32 v10, s45, v3
    ds_read_b128 v[192:195], v10 offset:0
    s_waitcnt lgkmcnt(3)
    v_mfma_f32_32x32x16_bf16 v[32:47], v[212:215], v[148:151], v[32:47]
    ds_read_b128 v[196:199], v10 offset:3072
    s_waitcnt lgkmcnt(3)
    v_mfma_f32_32x32x16_bf16 v[32:47], v[216:219], v[152:155], v[32:47]
    ds_read_b128 v[200:203], v10 offset:6144
    s_waitcnt lgkmcnt(3)
    v_mfma_f32_32x32x16_bf16 v[32:47], v[220:223], v[156:159], v[32:47]
    ds_read_b128 v[204:207], v10 offset:9216
    s_waitcnt lgkmcnt(3)
    v_mfma_f32_32x32x16_bf16 v[32:47], v[192:195], v[160:163], v[32:47]
    s_add_u32 s45, s35, 7
    s_and_b32 s45, s45, 7
    s_mul_i32 s45, s45, 12288
    s_add_u32 s45, s45, 65536
    v_add_u32 v11, s45, v3
    ds_read_b128 v[208:211], v11 offset:0
    s_waitcnt lgkmcnt(3)
    v_mfma_f32_32x32x16_bf16 v[32:47], v[196:199], v[164:167], v[32:47]
    ds_read_b128 v[212:215], v11 offset:3072
    s_waitcnt lgkmcnt(3)
    v_mfma_f32_32x32x16_bf16 v[32:47], v[200:203], v[168:171], v[32:47]
    ds_read_b128 v[216:219], v11 offset:6144
    s_waitcnt lgkmcnt(3)
    v_mfma_f32_32x32x16_bf16 v[32:47], v[204:207], v[172:175], v[32:47]
    ds_read_b128 v[220:223], v11 offset:9216
    s_barrier
    s_waitcnt lgkmcnt(3)
    v_mfma_f32_32x32x16_bf16 v[32:47], v[208:211], v[176:179], v[32:47]
    s_waitcnt lgkmcnt(2)
    v_mfma_f32_32x32x16_bf16 v[32:47], v[212:215], v[180:183], v[32:47]
    s_waitcnt lgkmcnt(1)
    v_mfma_f32_32x32x16_bf16 v[32:47], v[216:219], v[184:187], v[32:47]
    s_waitcnt lgkmcnt(0)
    v_mfma_f32_32x32x16_bf16 v[32:47], v[220:223], v[188:191], v[32:47]
    s_waitcnt vmcnt(0)
    s_nop 10
    v_pk_fma_f32 v[32:33], v[16:17], v[240:241], v[32:33] op_sel:[0,0,0] op_sel_hi:[1,0,1] neg_lo:[0,1,0] neg_hi:[0,1,0]
    v_pk_fma_f32 v[34:35], v[18:19], v[240:241], v[34:35] op_sel:[0,0,0] op_sel_hi:[1,0,1] neg_lo:[0,1,0] neg_hi:[0,1,0]
    v_pk_fma_f32 v[36:37], v[20:21], v[240:241], v[36:37] op_sel:[0,0,0] op_sel_hi:[1,0,1] neg_lo:[0,1,0] neg_hi:[0,1,0]
    v_pk_fma_f32 v[38:39], v[22:23], v[240:241], v[38:39] op_sel:[0,0,0] op_sel_hi:[1,0,1] neg_lo:[0,1,0] neg_hi:[0,1,0]
    v_pk_fma_f32 v[40:41], v[24:25], v[240:241], v[40:41] op_sel:[0,0,0] op_sel_hi:[1,0,1] neg_lo:[0,1,0] neg_hi:[0,1,0]
    v_pk_fma_f32 v[42:43], v[26:27], v[240:241], v[42:43] op_sel:[0,0,0] op_sel_hi:[1,0,1] neg_lo:[0,1,0] neg_hi:[0,1,0]
    v_pk_fma_f32 v[44:45], v[28:29], v[240:241], v[44:45] op_sel:[0,0,0] op_sel_hi:[1,0,1] neg_lo:[0,1,0] neg_hi:[0,1,0]
    v_pk_fma_f32 v[46:47], v[30:31], v[240:241], v[46:47] op_sel:[0,0,0] op_sel_hi:[1,0,1] neg_lo:[0,1,0] neg_hi:[0,1,0]
    v_max3_f32 v48, v32, v33, v34
    v_min3_f32 v56, v32, v33, v34
    v_max3_f32 v49, v35, v36, v37
    v_min3_f32 v57, v35, v36, v37
    v_max3_f32 v50, v38, v39, v40
    v_min3_f32 v58, v38, v39, v40
    v_max3_f32 v51, v41, v42, v43
    v_min3_f32 v59, v41, v42, v43
    v_max3_f32 v52, v44, v45, v46
    v_min3_f32 v60, v44, v45, v46
    v_max3_f32 v48, v48, v49, v50
    v_min3_f32 v56, v56, v57, v58
    v_max3_f32 v51, v51, v52, v47
    v_min3_f32 v59, v59, v60, v47
    v_max_f32 v224, v48, v51
    v_min_f32 v226, v56, v59
    v_mul_f32 v224, v224, v12
    v_mul_f32 v226, v226, v12
    v_pk_fma_f32 v[48:49], v[32:33], v[12:13], v[226:227] op_sel:[0,0,0] op_sel_hi:[1,0,0] neg_lo:[1,0,0] neg_hi:[1,0,0]
    v_pk_fma_f32 v[50:51], v[34:35], v[12:13], v[226:227] op_sel:[0,0,0] op_sel_hi:[1,0,0] neg_lo:[1,0,0] neg_hi:[1,0,0]
    v_pk_fma_f32 v[52:53], v[36:37], v[12:13], v[226:227] op_sel:[0,0,0] op_sel_hi:[1,0,0] neg_lo:[1,0,0] neg_hi:[1,0,0]
    v_pk_fma_f32 v[54:55], v[38:39], v[12:13], v[226:227] op_sel:[0,0,0] op_sel_hi:[1,0,0] neg_lo:[1,0,0] neg_hi:[1,0,0]
    v_pk_fma_f32 v[56:57], v[40:41], v[12:13], v[226:227] op_sel:[0,0,0] op_sel_hi:[1,0,0] neg_lo:[1,0,0] neg_hi:[1,0,0]
    v_pk_fma_f32 v[58:59], v[42:43], v[12:13], v[226:227] op_sel:[0,0,0] op_sel_hi:[1,0,0] neg_lo:[1,0,0] neg_hi:[1,0,0]
    v_pk_fma_f32 v[60:61], v[44:45], v[12:13], v[226:227] op_sel:[0,0,0] op_sel_hi:[1,0,0] neg_lo:[1,0,0] neg_hi:[1,0,0]
    v_pk_fma_f32 v[62:63], v[46:47], v[12:13], v[226:227] op_sel:[0,0,0] op_sel_hi:[1,0,0] neg_lo:[1,0,0] neg_hi:[1,0,0]
    v_pk_fma_f32 v[32:33], v[32:33], v[12:13], v[224:225] op_sel:[0,0,0] op_sel_hi:[1,0,0] neg_lo:[0,0,1] neg_hi:[0,0,1]
    v_pk_fma_f32 v[34:35], v[34:35], v[12:13], v[224:225] op_sel:[0,0,0] op_sel_hi:[1,0,0] neg_lo:[0,0,1] neg_hi:[0,0,1]
    v_pk_fma_f32 v[36:37], v[36:37], v[12:13], v[224:225] op_sel:[0,0,0] op_sel_hi:[1,0,0] neg_lo:[0,0,1] neg_hi:[0,0,1]
    v_pk_fma_f32 v[38:39], v[38:39], v[12:13], v[224:225] op_sel:[0,0,0] op_sel_hi:[1,0,0] neg_lo:[0,0,1] neg_hi:[0,0,1]
    v_pk_fma_f32 v[40:41], v[40:41], v[12:13], v[224:225] op_sel:[0,0,0] op_sel_hi:[1,0,0] neg_lo:[0,0,1] neg_hi:[0,0,1]
    v_pk_fma_f32 v[42:43], v[42:43], v[12:13], v[224:225] op_sel:[0,0,0] op_sel_hi:[1,0,0] neg_lo:[0,0,1] neg_hi:[0,0,1]
    v_pk_fma_f32 v[44:45], v[44:45], v[12:13], v[224:225] op_sel:[0,0,0] op_sel_hi:[1,0,0] neg_lo:[0,0,1] neg_hi:[0,0,1]
    v_pk_fma_f32 v[46:47], v[46:47], v[12:13], v[224:225] op_sel:[0,0,0] op_sel_hi:[1,0,0] neg_lo:[0,0,1] neg_hi:[0,0,1]
    v_exp_f32 v48, v48
    v_exp_f32 v49, v49
    v_exp_f32 v50, v50
    v_exp_f32 v51, v51
    v_exp_f32 v52, v52
    v_exp_f32 v53, v53
    v_exp_f32 v54, v54
    v_exp_f32 v55, v55
    v_exp_f32 v56, v56
    v_exp_f32 v57, v57
    v_exp_f32 v58, v58
    v_exp_f32 v59, v59
    v_exp_f32 v60, v60
    v_exp_f32 v61, v61
    v_exp_f32 v62, v62
    v_exp_f32 v63, v63
    v_exp_f32 v32, v32
    v_exp_f32 v33, v33
    v_exp_f32 v34, v34
    v_exp_f32 v35, v35
    v_exp_f32 v36, v36
    v_exp_f32 v37, v37
    v_exp_f32 v38, v38
    v_exp_f32 v39, v39
    v_exp_f32 v40, v40
    v_exp_f32 v41, v41
    v_exp_f32 v42, v42
    v_exp_f32 v43, v43
    v_exp_f32 v44, v44
    v_exp_f32 v45, v45
    v_exp_f32 v46, v46
    v_exp_f32 v47, v47
    v_pk_add_f32 v[232:233], v[48:49], v[50:51]
    v_pk_add_f32 v[234:235], v[52:53], v[54:55]
    v_pk_add_f32 v[228:229], v[32:33], v[34:35]
    v_pk_add_f32 v[230:231], v[36:37], v[38:39]
    v_pk_add_f32 v[232:233], v[232:233], v[56:57]
    v_pk_add_f32 v[234:235], v[234:235], v[58:59]
    v_pk_add_f32 v[228:229], v[228:229], v[40:41]
    v_pk_add_f32 v[230:231], v[230:231], v[42:43]
    v_pk_add_f32 v[232:233], v[232:233], v[60:61]
    v_pk_add_f32 v[234:235], v[234:235], v[62:63]
    v_pk_add_f32 v[228:229], v[228:229], v[44:45]
    v_pk_add_f32 v[230:231], v[230:231], v[46:47]
    v_pk_add_f32 v[226:227], v[232:233], v[234:235]
    v_pk_add_f32 v[224:225], v[228:229], v[230:231]
    v_add_f32 v226, v226, v227
    v_add_f32 v224, v224, v225
    v_rcp_f32 v226, v226
    v_rcp_f32 v224, v224
    v_pk_mul_f32 v[48:49], v[48:49], v[226:227] op_sel:[0,0] op_sel_hi:[1,0]
    v_pk_mul_f32 v[50:51], v[50:51], v[226:227] op_sel:[0,0] op_sel_hi:[1,0]
    v_pk_mul_f32 v[52:53], v[52:53], v[226:227] op_sel:[0,0] op_sel_hi:[1,0]
    v_pk_mul_f32 v[54:55], v[54:55], v[226:227] op_sel:[0,0] op_sel_hi:[1,0]
    v_pk_mul_f32 v[56:57], v[56:57], v[226:227] op_sel:[0,0] op_sel_hi:[1,0]
    v_pk_mul_f32 v[58:59], v[58:59], v[226:227] op_sel:[0,0] op_sel_hi:[1,0]
    v_pk_mul_f32 v[60:61], v[60:61], v[226:227] op_sel:[0,0] op_sel_hi:[1,0]
    v_pk_mul_f32 v[62:63], v[62:63], v[226:227] op_sel:[0,0] op_sel_hi:[1,0]
    v_pk_mul_f32 v[32:33], v[32:33], v[224:225] op_sel:[0,0] op_sel_hi:[1,0]
    v_pk_mul_f32 v[34:35], v[34:35], v[224:225] op_sel:[0,0] op_sel_hi:[1,0]
    v_pk_mul_f32 v[36:37], v[36:37], v[224:225] op_sel:[0,0] op_sel_hi:[1,0]
    v_pk_mul_f32 v[38:39], v[38:39], v[224:225] op_sel:[0,0] op_sel_hi:[1,0]
    v_pk_mul_f32 v[40:41], v[40:41], v[224:225] op_sel:[0,0] op_sel_hi:[1,0]
    v_pk_mul_f32 v[42:43], v[42:43], v[224:225] op_sel:[0,0] op_sel_hi:[1,0]
    v_pk_mul_f32 v[44:45], v[44:45], v[224:225] op_sel:[0,0] op_sel_hi:[1,0]
    v_pk_mul_f32 v[46:47], v[46:47], v[224:225] op_sel:[0,0] op_sel_hi:[1,0]
    v_cvt_pk_bf16_f32 v48, v48, v49
    v_cvt_pk_bf16_f32 v49, v50, v51
    v_cvt_pk_bf16_f32 v50, v52, v53
    v_cvt_pk_bf16_f32 v51, v54, v55
    v_cvt_pk_bf16_f32 v52, v56, v57
    v_cvt_pk_bf16_f32 v53, v58, v59
    v_cvt_pk_bf16_f32 v54, v60, v61
    v_cvt_pk_bf16_f32 v55, v62, v63
    v_cvt_pk_bf16_f32 v32, v32, v33
    v_cvt_pk_bf16_f32 v33, v34, v35
    v_cvt_pk_bf16_f32 v34, v36, v37
    v_cvt_pk_bf16_f32 v35, v38, v39
    v_cvt_pk_bf16_f32 v36, v40, v41
    v_cvt_pk_bf16_f32 v37, v42, v43
    v_cvt_pk_bf16_f32 v38, v44, v45
    v_cvt_pk_bf16_f32 v39, v46, v47
    v_lshlrev_b32 v11, 4, v8
    v_lshl_add_u32 v11, v9, 11, v11
    s_cmp_eq_u32 s93, 1
    s_cbranch_scc1 mg_loc40
    buffer_store_dwordx4 v[32:35], v11, s[28:31], s38 offen offset:0 sc1
    buffer_store_dwordx4 v[36:39], v11, s[28:31], s38 offen offset:512 sc1
    buffer_store_dwordx4 v[48:51], v11, s[28:31], s38 offen offset:1024 sc1
    buffer_store_dwordx4 v[52:55], v11, s[28:31], s38 offen offset:1536 sc1
    s_branch mg_loc241
mg_loc40:
    buffer_store_dwordx4 v[32:35], v11, s[28:31], s38 offen offset:0
    buffer_store_dwordx4 v[36:39], v11, s[28:31], s38 offen offset:512
    buffer_store_dwordx4 v[48:51], v11, s[28:31], s38 offen offset:1024
    buffer_store_dwordx4 v[52:55], v11, s[28:31], s38 offen offset:1536
mg_loc241:
    s_mov_b32 s34, s39
    s_branch mg_p2e36
mg_H35:
    s_barrier
    s_cmp_lg_u32 s50, 0
    s_cbranch_scc1 mg_nwo42
    s_lshl_b32 s4, s36, 16
    s_lshl_b32 s5, s33, 12
    s_add_u32 s4, s4, s5
    s_add_u32 s4, s4, s55
    s_waitcnt vmcnt(0)
    v_lshlrev_b32 v4, 6, v2
    buffer_load_dword v5, v4, s[28:31], s4 offen sc1
    s_lshr_b32 s4, s2, 4
    s_mul_i32 s4, s4, 98304
    s_mul_i32 s5, s49, 24576
    s_add_u32 s4, s4, s5
    s_add_u32 s4, s4, 16777216
    s_add_u32 m0, s5, 65536
    s_nop 0
    buffer_load_dwordx4 v3, s[28:31], s4 offen sc1 lds
    buffer_load_dwordx4 v3, s[28:31], s4 offen offset:3072 sc1 lds
    s_add_u32 s4, s4, 6144
    s_add_u32 m0, s5, 71680
    s_nop 0
    buffer_load_dwordx4 v3, s[28:31], s4 offen sc1 lds
    buffer_load_dwordx4 v3, s[28:31], s4 offen offset:3072 sc1 lds
    s_add_u32 s4, s4, 6144
    s_add_u32 m0, s5, 77824
    s_nop 0
    buffer_load_dwordx4 v3, s[28:31], s4 offen sc1 lds
    buffer_load_dwordx4 v3, s[28:31], s4 offen offset:3072 sc1 lds
    s_add_u32 s4, s4, 6144
    s_add_u32 m0, s5, 83968
    s_nop 0
    buffer_load_dwordx4 v3, s[28:31], s4 offen sc1 lds
    buffer_load_dwordx4 v3, s[28:31], s4 offen offset:3072 sc1 lds
    s_lshr_b32 s43, s2, 6
    s_lshl_b32 s43, s43, 2
    s_add_u32 s43, s43, s49
    s_lshl_b32 s43, s43, 15
    s_add_u32 s43, s43, 18366464
    buffer_load_dwordx4 v[176:179], v3, s[28:31], s43 offen offset:0 sc1
    buffer_load_dwordx4 v[180:183], v3, s[28:31], s43 offen offset:1024 sc1
    buffer_load_dwordx4 v[184:187], v3, s[28:31], s43 offen offset:2048 sc1
    buffer_load_dwordx4 v[188:191], v3, s[28:31], s43 offen offset:3072 sc1
    s_add_u32 s43, s43, 4096
    buffer_load_dwordx4 v[192:195], v3, s[28:31], s43 offen offset:0 sc1
    buffer_load_dwordx4 v[196:199], v3, s[28:31], s43 offen offset:1024 sc1
    buffer_load_dwordx4 v[200:203], v3, s[28:31], s43 offen offset:2048 sc1
    buffer_load_dwordx4 v[204:207], v3, s[28:31], s43 offen offset:3072 sc1
    s_add_u32 s43, s43, 4096
    buffer_load_dwordx4 v[208:211], v3, s[28:31], s43 offen offset:0 sc1
    buffer_load_dwordx4 v[212:215], v3, s[28:31], s43 offen offset:1024 sc1
    buffer_load_dwordx4 v[216:219], v3, s[28:31], s43 offen offset:2048 sc1
    buffer_load_dwordx4 v[220:223], v3, s[28:31], s43 offen offset:3072 sc1
    s_add_u32 s43, s43, 4096
    buffer_load_dwordx4 v[224:227], v3, s[28:31], s43 offen offset:0 sc1
    buffer_load_dwordx4 v[228:231], v3, s[28:31], s43 offen offset:1024 sc1
    buffer_load_dwordx4 v[232:235], v3, s[28:31], s43 offen offset:2048 sc1
    buffer_load_dwordx4 v[236:239], v3, s[28:31], s43 offen offset:3072 sc1
    s_waitcnt vmcnt(16)
mg_nwo42:
    s_barrier
    s_lshl_b32 s38, s33, 4
    s_mul_i32 s38, s38, 4352
    s_add_u32 s38, s38, s63
    v_lshrrev_b32 v10, 4, v2
    v_mul_u32_u24 v6, 4352, v10
    v_mul_u32_u24 v10, 34816, v10
    v_and_b32 v11, 15, v2
    s_cmp_lg_u32 s47, 4
    s_cbranch_scc1 mg_rz46
    s_lshr_b32 s5, s32, 2
    s_and_b32 s6, s5, 1
    s_lshr_b32 s7, s5, 1
    s_lshl_b32 s39, s33, 2
    s_lshl_b32 s6, s6, 1
    s_add_u32 s39, s39, s6
    s_add_u32 s39, s39, s7
    s_and_b32 s6, s32, 3
    s_lshl_b32 s39, s39, 9
    s_lshl_b32 s6, s6, 7
    s_add_u32 s39, s39, s6
    s_lshl_b32 s5, s5, 10
    s_add_u32 s38, s38, s5
    s_bfe_u32 s5, s32, 0x10001
    s_lshl_b32 s5, s5, 9
    s_add_u32 s38, s38, s5
    s_and_b32 s5, s32, 1
    s_lshl_b32 s5, s5, 7
    s_add_u32 s38, s38, s5
    v_bfe_u32 v7, v0, 1, 3
    v_lshl_add_u32 v6, v7, 4, v6
    v_and_b32 v7, 1, v0
    v_lshl_add_u32 v6, v7, 8, v6
    s_branch mg_rg47
mg_rz46:
    s_add_u32 s38, s38, 4096
    s_lshl_b32 s39, s33, 7
    s_add_u32 s39, s39, 32768
    v_and_b32 v7, 3, v0
    v_lshl_add_u32 v6, v7, 4, v6
    v_bfe_u32 v7, v0, 3, 1
    v_lshl_add_u32 v6, v7, 6, v6
    v_bfe_u32 v7, v0, 2, 1
    v_lshl_add_u32 v6, v7, 7, v6
mg_rg47:
    s_add_u32 s39, s39, s54
    s_add_u32 s45, s39, 139264
    v_lshl_add_u32 v7, v11, 3, v10
    s_add_u32 s40, s38, 17408
    s_add_u32 s41, s38, 34816
    s_add_u32 s42, s38, 52224
    s_setprio 2
    s_barrier
    ds_read_b64_tr_b16 v[64:65], v14 offset:0
    ds_read_b64_tr_b16 v[66:67], v14 offset:512
    ds_read_b128 v[48:51], v12 offset:0
    ds_read_b64_tr_b16 v[68:69], v14 offset:16384
    ds_read_b64_tr_b16 v[70:71], v14 offset:16896
    ds_read_b128 v[52:55], v12 offset:16384
    ds_read_b64_tr_b16 v[72:73], v14 offset:32768
    ds_read_b64_tr_b16 v[74:75], v14 offset:33280
    ds_read_b128 v[56:59], v12 offset:32768
    ds_read_b64_tr_b16 v[76:77], v14 offset:49152
    ds_read_b64_tr_b16 v[78:79], v14 offset:49664
    ds_read_b128 v[60:63], v12 offset:49152
    s_waitcnt lgkmcnt(10)
    v_mfma_f32_16x16x32_bf16 v[20:23], v[64:67], v[80:83], 0
    s_waitcnt lgkmcnt(9)
    v_mfma_f32_16x16x32_bf16 v[16:19], v[64:67], v[48:51], 0
    s_waitcnt lgkmcnt(7)
    v_mfma_f32_16x16x32_bf16 v[20:23], v[68:71], v[80:83], v[20:23]
    s_waitcnt lgkmcnt(6)
    v_mfma_f32_16x16x32_bf16 v[16:19], v[68:71], v[52:55], v[16:19]
    s_waitcnt lgkmcnt(4)
    v_mfma_f32_16x16x32_bf16 v[20:23], v[72:75], v[80:83], v[20:23]
    s_waitcnt lgkmcnt(3)
    v_mfma_f32_16x16x32_bf16 v[16:19], v[72:75], v[56:59], v[16:19]
    s_waitcnt lgkmcnt(1)
    v_mfma_f32_16x16x32_bf16 v[20:23], v[76:79], v[80:83], v[20:23]
    s_waitcnt lgkmcnt(0)
    v_mfma_f32_16x16x32_bf16 v[16:19], v[76:79], v[60:63], v[16:19]
    s_nop 7
    buffer_store_dwordx4 v[16:19], v3, s[28:31], s46 offen sc1
    s_mov_b32 exec_lo, 0x00010001
    s_mov_b32 exec_hi, 0x00010001
    buffer_store_dwordx4 v[20:23], v2, s[28:31], s44 offen sc1
    s_mov_b64 exec, -1
    s_barrier
    s_cmp_eq_u32 s47, 4
    s_cbranch_scc1 mg_rl43x
    s_cmp_lg_u32 s47, 5
    s_cbranch_scc1 mg_rx44
    s_and_b32 s6, s33, 7
    s_lshl_b32 s6, s6, 1
    s_bfe_u32 s7, s33, 0x10002
    s_or_b32 s6, s6, s7
    s_cmp_lg_u32 s32, s6
    s_cbranch_scc1 mg_rx44
mg_rl43x:
    s_mov_b32 s5, 0x40000
    s_waitcnt vmcnt(0)
mg_rl43:
    s_sleep 2
    buffer_load_dwordx4 v[16:19], v6, s[28:31], s38 offen sc1
    buffer_load_dwordx4 v[20:23], v6, s[28:31], s40 offen sc1
    buffer_load_dwordx4 v[24:27], v6, s[28:31], s41 offen sc1
    buffer_load_dwordx4 v[28:31], v6, s[28:31], s42 offen sc1
    s_waitcnt vmcnt(2)
    v_pk_add_f32 v[16:17], v[16:17], v[20:21]
    v_pk_add_f32 v[18:19], v[18:19], v[22:23]
    s_waitcnt vmcnt(0)
    v_pk_add_f32 v[24:25], v[24:25], v[28:29]
    v_pk_add_f32 v[26:27], v[26:27], v[30:31]
    v_pk_add_f32 v[16:17], v[16:17], v[24:25]
    v_pk_add_f32 v[18:19], v[18:19], v[26:27]
    s_nop 1
    v_permlane32_swap_b32 v16, v18
    v_permlane32_swap_b32 v17, v19
    v_pk_add_f32 v[16:17], v[16:17], v[18:19]
    v_cmp_u_f32 vcc, v16, v17
    s_cbranch_vccz mg_ok45
    s_sub_u32 s5, s5, 1
    s_cbranch_scc0 mg_rl43
mg_ok45:
    v_mov_b32 v18, v16
    v_mov_b32 v19, v17
    s_nop 0
    v_permlane16_swap_b32 v16, v18
    v_permlane16_swap_b32 v17, v19
    v_pk_add_f32 v[16:17], v[16:17], v[18:19]
    v_cvt_pk_bf16_f32 v16, v16, v17
    v_mov_b32 v17, v16
    s_nop 1
    v_permlane32_swap_b32 v16, v17
    s_mov_b64 exec, 0xffff
    buffer_store_dwordx2 v[16:17], v7, s[28:31], s39 offen sc1
    s_mov_b64 exec, -1
mg_rx44:
    s_setprio 0
mg_p2e36:
    s_and_b32 s3, s2, 7
    s_lshl_b32 s3, s3, 3
    s_bfe_u32 s4, s2, 0x30003
    s_add_u32 s32, s3, s4
    s_lshr_b32 s33, s2, 6
    s_lshl_b32 s44, s32, 15
    s_lshl_b32 s45, s33, 13
    s_add_u32 s44, s44, s45
    s_add_u32 s44, s44, s52
    s_add_u32 s44, s44, 0x200000
    s_lshl_b32 s45, s47, 10
    s_add_u32 s46, s44, s45
    s_add_u32 m0, s45, 34816
    v_lshlrev_b32 v12, 2, v2
    buffer_load_dwordx4 v3, s[28:31], s46 offen sc1 lds
    s_lshl_b32 s41, s32, 11
    s_add_u32 s41, s41, s62
    s_lshl_b32 s5, s47, 8
    s_add_u32 s41, s41, s5
    v_and_b32 v6, 32, v2
    v_lshlrev_b32 v6, 2, v6
    v_mov_b32 v7, 1
    s_lshl_b32 s35, s47, 12
    s_add_u32 s36, s35, s54
    s_add_u32 s37, s5, s54
    s_add_u32 s37, s37, 32768
    s_lshl_b32 s42, s32, 16
    s_lshl_b32 s6, s47, 13
    s_add_u32 s42, s42, s6
    s_add_u32 s42, s42, s55
    s_add_u32 s6, s5, 32768
    v_add_u32 v13, s6, v12
    v_and_b32 v9, 31, v0
    v_bfe_u32 v10, v0, 5, 1
    v_lshl_add_u32 v14, v9, 4, s35
    v_lshl_add_u32 v14, v10, 8, v14
    v_lshl_add_u32 v15, v10, 4, s6
    v_cmp_gt_u32 vcc, 16, v9
    s_nop 1
    v_cndmask_b32 v40, v15, v14, vcc
    v_mov_b32 v14, 0x200
    v_cndmask_b32 v14, 32, v14, vcc
    v_add_u32 v41, v40, v14
    v_add_u32 v42, v41, v14
    v_add_u32 v43, v42, v14
    v_add_u32 v44, v43, v14
    v_add_u32 v45, v44, v14
    v_add_u32 v46, v45, v14
    v_add_u32 v47, v46, v14
    v_add_u32 v8, s35, v3
    v_bfe_u32 v14, v0, 2, 2
    v_and_b32 v15, 3, v0
    v_lshl_add_u32 v11, v10, 4, v14
    v_lshlrev_b32 v11, 6, v11
    v_lshl_add_u32 v11, v15, 3, v11
    v_bfe_u32 v5, v0, 4, 1
    v_lshl_add_u32 v11, v5, 5, v11
    s_lshl_b32 s4, s49, 11
    s_add_u32 s4, s4, 34816
    v_add_u32 v11, s4, v11
    s_cmp_ge_u32 s47, 4
    s_cbranch_scc1 mg_hh48
    v_mov_b32 v5, 0
    s_waitcnt vmcnt(1)
    s_mov_b64 exec, 1
    s_cmp_eq_u32 s93, 1
    s_cbranch_scc1 mg_hh48a
    buffer_store_dword v7, v5, s[28:31], s34 offen sc1
    s_branch mg_hh48b
mg_hh48a:
    buffer_store_dword v7, v5, s[28:31], s34 offen
mg_hh48b:
    s_mov_b64 exec, -1
mg_hh48:
    s_mov_b32 s5, 0x40000
mg_pl49:
    s_waitcnt vmcnt(3)
    buffer_load_dword v4, v6, s[28:31], s41 offen sc1
    s_sub_u32 s5, s5, 1
    s_cbranch_scc1 mg_pd50
    s_waitcnt vmcnt(0)
    v_cmp_ne_u32 vcc, 1, v4
    s_cbranch_vccz mg_pd50
    s_sleep 2
    s_branch mg_pl49
mg_pd50:
    buffer_load_dwordx4 v[80:83], v3, s[28:31], s42 offen offset:0 sc1
    buffer_load_dwordx4 v[84:87], v3, s[28:31], s42 offen offset:1024 sc1
    buffer_load_dwordx4 v[88:91], v3, s[28:31], s42 offen offset:2048 sc1
    buffer_load_dwordx4 v[92:95], v3, s[28:31], s42 offen offset:3072 sc1
    s_add_u32 s42, s42, 4096
    buffer_load_dwordx4 v[96:99], v3, s[28:31], s42 offen offset:0 sc1
    buffer_load_dwordx4 v[100:103], v3, s[28:31], s42 offen offset:1024 sc1
    buffer_load_dwordx4 v[104:107], v3, s[28:31], s42 offen offset:2048 sc1
    buffer_load_dwordx4 v[108:111], v3, s[28:31], s42 offen offset:3072 sc1
    s_barrier
    s_mov_b32 m0, s35
    s_mov_b32 s5, 0x40000
mg_kl51:
    buffer_load_dwordx4 v3, s[28:31], s36 offen offset:0 sc1 lds
    buffer_load_dwordx4 v3, s[28:31], s36 offen offset:1024 sc1 lds
    buffer_load_dwordx4 v3, s[28:31], s36 offen offset:2048 sc1 lds
    buffer_load_dwordx4 v3, s[28:31], s36 offen offset:3072 sc1 lds
    s_waitcnt vmcnt(12)
    buffer_load_dword v4, v12, s[28:31], s37 offen sc1
    s_waitcnt vmcnt(0)
    ds_write_b32 v13, v4
    ds_read_b128 v[48:51], v40
    ds_read_b128 v[52:55], v41
    ds_read_b128 v[56:59], v42
    ds_read_b128 v[60:63], v43
    ds_read_b128 v[64:67], v44
    ds_read_b128 v[68:71], v45
    ds_read_b128 v[72:75], v46
    ds_read_b128 v[76:79], v47
    s_waitcnt lgkmcnt(7)
    v_mfma_f32_32x32x16_bf16 v[16:31], v[48:51], v[80:83], 0
    s_waitcnt lgkmcnt(6)
    v_mfma_f32_32x32x16_bf16 v[16:31], v[52:55], v[84:87], v[16:31]
    v_max3_u32 v5, v48, v49, v50
    v_max3_u32 v6, v51, v52, v53
    v_max3_u32 v5, v5, v54, v55
    s_waitcnt lgkmcnt(5)
    v_max3_u32 v6, v6, v56, v57
    v_max3_u32 v5, v5, v58, v59
    s_waitcnt lgkmcnt(4)
    v_max3_u32 v6, v6, v60, v61
    v_max3_u32 v5, v5, v62, v63
    s_waitcnt lgkmcnt(3)
    v_max3_u32 v6, v6, v64, v65
    v_max3_u32 v5, v5, v66, v67
    s_waitcnt lgkmcnt(2)
    v_max3_u32 v6, v6, v68, v69
    v_max3_u32 v5, v5, v70, v71
    s_waitcnt lgkmcnt(1)
    v_max3_u32 v6, v6, v72, v73
    v_max3_u32 v5, v5, v74, v75
    s_waitcnt lgkmcnt(0)
    v_max3_u32 v6, v6, v76, v77
    v_max3_u32 v5, v5, v78, v79
    v_max_u32 v5, v5, v6
    v_cmp_eq_u32 vcc, -1, v5
    s_cbranch_vccz mg_ko52
    s_sub_u32 s5, s5, 1
    s_cbranch_scc0 mg_kl51
mg_ko52:
    v_mfma_f32_32x32x16_bf16 v[32:47], v[56:59], v[88:91], 0
    v_mfma_f32_32x32x16_bf16 v[32:47], v[60:63], v[92:95], v[32:47]
    ds_read_b64_tr_b16 v[48:49], v11 offset:0
    ds_read_b64_tr_b16 v[50:51], v11 offset:256
    ds_read_b64_tr_b16 v[52:53], v11 offset:512
    ds_read_b64_tr_b16 v[54:55], v11 offset:768
    v_add_f32 v24, 0x358637bd, v24
    v_rcp_f32 v24, v24
    s_nop 0
    v_mul_f32 v16, v16, v24
    v_mul_f32 v17, v17, v24
    v_mul_f32 v18, v18, v24
    v_mul_f32 v19, v19, v24
    v_mul_f32 v20, v20, v24
    v_mul_f32 v21, v21, v24
    v_mul_f32 v22, v22, v24
    v_mul_f32 v23, v23, v24
    v_cvt_pk_bf16_f32 v28, v16, v17
    v_cvt_pk_bf16_f32 v29, v18, v19
    v_cvt_pk_bf16_f32 v30, v20, v21
    v_cvt_pk_bf16_f32 v31, v22, v23
    ds_write_b128 v8, v[28:31] offset:0
    v_mfma_f32_32x32x16_bf16 v[16:31], v[64:67], v[96:99], 0
    v_mfma_f32_32x32x16_bf16 v[16:31], v[68:71], v[100:103], v[16:31]
    v_add_f32 v40, 0x358637bd, v40
    v_rcp_f32 v40, v40
    s_nop 0
    v_mul_f32 v32, v32, v40
    v_mul_f32 v33, v33, v40
    v_mul_f32 v34, v34, v40
    v_mul_f32 v35, v35, v40
    v_mul_f32 v36, v36, v40
    v_mul_f32 v37, v37, v40
    v_mul_f32 v38, v38, v40
    v_mul_f32 v39, v39, v40
    v_cvt_pk_bf16_f32 v44, v32, v33
    v_cvt_pk_bf16_f32 v45, v34, v35
    v_cvt_pk_bf16_f32 v46, v36, v37
    v_cvt_pk_bf16_f32 v47, v38, v39
    ds_write_b128 v8, v[44:47] offset:1024
    v_mfma_f32_32x32x16_bf16 v[32:47], v[72:75], v[104:107], 0
    v_mfma_f32_32x32x16_bf16 v[32:47], v[76:79], v[108:111], v[32:47]
    v_add_f32 v24, 0x358637bd, v24
    v_rcp_f32 v24, v24
    s_nop 0
    v_mul_f32 v16, v16, v24
    v_mul_f32 v17, v17, v24
    v_mul_f32 v18, v18, v24
    v_mul_f32 v19, v19, v24
    v_mul_f32 v20, v20, v24
    v_mul_f32 v21, v21, v24
    v_mul_f32 v22, v22, v24
    v_mul_f32 v23, v23, v24
    v_cvt_pk_bf16_f32 v28, v16, v17
    v_cvt_pk_bf16_f32 v29, v18, v19
    v_cvt_pk_bf16_f32 v30, v20, v21
    v_cvt_pk_bf16_f32 v31, v22, v23
    ds_write_b128 v8, v[28:31] offset:2048
    v_add_f32 v40, 0x358637bd, v40
    v_rcp_f32 v40, v40
    s_nop 0
    v_mul_f32 v32, v32, v40
    v_mul_f32 v33, v33, v40
    v_mul_f32 v34, v34, v40
    v_mul_f32 v35, v35, v40
    v_mul_f32 v36, v36, v40
    v_mul_f32 v37, v37, v40
    v_mul_f32 v38, v38, v40
    v_mul_f32 v39, v39, v40
    v_cvt_pk_bf16_f32 v44, v32, v33
    v_cvt_pk_bf16_f32 v45, v34, v35
    v_cvt_pk_bf16_f32 v46, v36, v37
    v_cvt_pk_bf16_f32 v47, v38, v39
    ds_write_b128 v8, v[44:47] offset:3072
    s_waitcnt lgkmcnt(0)
    s_barrier
    s_cmp_ge_u32 s47, 4
    s_cbranch_scc1 mg_p3g54
    s_cmp_eq_u32 s50, 0
    s_cbranch_scc1 mg_p3e53f
    s_cmp_lg_u32 s47, 0
    s_cbranch_scc1 mg_fin
    s_cmp_ge_u32 s2, 8
    s_cbranch_scc1 mg_fin
    buffer_wbl2 sc1
    s_branch mg_fin
mg_p3g54:
    ds_read_b128 v[64:67], v3 offset:0
    ds_read_b128 v[68:71], v3 offset:1024
    ds_read_b128 v[72:75], v3 offset:2048
    ds_read_b128 v[76:79], v3 offset:3072
    v_lshlrev_b32 v16, 16, v48
    v_and_b32 v17, 0xffff0000, v48
    v_lshlrev_b32 v18, 16, v49
    v_and_b32 v19, 0xffff0000, v49
    v_lshlrev_b32 v20, 16, v50
    v_and_b32 v21, 0xffff0000, v50
    v_lshlrev_b32 v22, 16, v51
    v_and_b32 v23, 0xffff0000, v51
    v_lshlrev_b32 v24, 16, v52
    v_and_b32 v25, 0xffff0000, v52
    v_lshlrev_b32 v26, 16, v53
    v_and_b32 v27, 0xffff0000, v53
    v_lshlrev_b32 v28, 16, v54
    v_and_b32 v29, 0xffff0000, v54
    v_lshlrev_b32 v30, 16, v55
    v_and_b32 v31, 0xffff0000, v55
    s_waitcnt lgkmcnt(3)
    s_nop 0
    v_mfma_f32_32x32x16_bf16 v[16:31], v[112:115], v[64:67], v[16:31]
    ds_read_b128 v[80:83], v3 offset:4096
    ds_read_b128 v[84:87], v3 offset:5120
    s_waitcnt lgkmcnt(4)
    v_mfma_f32_32x32x16_bf16 v[16:31], v[116:119], v[68:71], v[16:31]
    ds_read_b128 v[88:91], v3 offset:6144
    ds_read_b128 v[92:95], v3 offset:7168
    s_waitcnt lgkmcnt(5)
    v_mfma_f32_32x32x16_bf16 v[16:31], v[120:123], v[72:75], v[16:31]
    ds_read_b128 v[64:67], v3 offset:8192
    ds_read_b128 v[68:71], v3 offset:9216
    s_waitcnt lgkmcnt(6)
    v_mfma_f32_32x32x16_bf16 v[16:31], v[124:127], v[76:79], v[16:31]
    ds_read_b128 v[72:75], v3 offset:10240
    ds_read_b128 v[76:79], v3 offset:11264
    s_waitcnt lgkmcnt(7)
    v_mfma_f32_32x32x16_bf16 v[16:31], v[128:131], v[80:83], v[16:31]
    ds_read_b128 v[80:83], v3 offset:12288
    s_waitcnt lgkmcnt(7)
    v_mfma_f32_32x32x16_bf16 v[16:31], v[132:135], v[84:87], v[16:31]
    ds_read_b128 v[84:87], v3 offset:13312
    s_waitcnt lgkmcnt(7)
    v_mfma_f32_32x32x16_bf16 v[16:31], v[136:139], v[88:91], v[16:31]
    ds_read_b128 v[88:91], v3 offset:14336
    v_mul_u32_u24 v96, 80, v9
    v_lshl_add_u32 v96, v10, 5, v96
    s_waitcnt lgkmcnt(7)
    v_mfma_f32_32x32x16_bf16 v[16:31], v[140:143], v[92:95], v[16:31]
    ds_read_b128 v[92:95], v3 offset:15360
    s_mul_i32 s4, s49, 2560
    s_add_u32 s4, s4, 43008
    s_waitcnt lgkmcnt(7)
    v_mfma_f32_32x32x16_bf16 v[16:31], v[144:147], v[64:67], v[16:31]
    ds_read_b128 v[64:67], v3 offset:16384
    v_add_u32 v96, s4, v96
    v_lshrrev_b32 v101, 4, v2
    s_waitcnt lgkmcnt(7)
    v_mfma_f32_32x32x16_bf16 v[16:31], v[148:151], v[68:71], v[16:31]
    ds_read_b128 v[68:71], v3 offset:17408
    v_lshl_add_u32 v97, v101, 3, v14
    v_mul_u32_u24 v97, 80, v97
    s_waitcnt lgkmcnt(7)
    v_mfma_f32_32x32x16_bf16 v[16:31], v[152:155], v[72:75], v[16:31]
    ds_read_b128 v[72:75], v3 offset:18432
    v_lshl_add_u32 v97, v15, 3, v97
    v_add_u32 v97, s4, v97
    s_waitcnt lgkmcnt(7)
    v_mfma_f32_32x32x16_bf16 v[16:31], v[156:159], v[76:79], v[16:31]
    ds_read_b128 v[76:79], v3 offset:19456
    v_lshlrev_b32 v98, 2, v10
    v_and_b32 v102, 1, v9
    s_waitcnt lgkmcnt(7)
    v_mfma_f32_32x32x16_bf16 v[16:31], v[160:163], v[80:83], v[16:31]
    ds_read_b128 v[80:83], v3 offset:20480
    v_lshl_add_u32 v98, v102, 3, v98
    v_lshrrev_b32 v102, 2, v9
    s_waitcnt lgkmcnt(7)
    v_mfma_f32_32x32x16_bf16 v[16:31], v[164:167], v[84:87], v[16:31]
    ds_read_b128 v[84:87], v3 offset:21504
    v_lshl_add_u32 v98, v102, 4, v98
    v_bfe_u32 v102, v9, 1, 1
    s_waitcnt lgkmcnt(7)
    v_mfma_f32_32x32x16_bf16 v[16:31], v[168:171], v[88:91], v[16:31]
    ds_read_b128 v[88:91], v3 offset:22528
    v_lshl_add_u32 v98, v102, 13, v98
    s_lshl_b32 s38, s32, 7
    s_waitcnt lgkmcnt(7)
    v_mfma_f32_32x32x16_bf16 v[16:31], v[172:175], v[92:95], v[16:31]
    ds_read_b128 v[92:95], v3 offset:23552
    s_add_u32 s38, s38, 18874368
    v_and_b32 v99, 15, v0
    s_waitcnt lgkmcnt(7)
    v_mfma_f32_32x32x16_bf16 v[16:31], v[176:179], v[64:67], v[16:31]
    ds_read_b128 v[64:67], v3 offset:24576
    v_lshlrev_b32 v99, 6, v99
    v_lshl_add_u32 v99, v101, 4, v99
    s_waitcnt lgkmcnt(7)
    v_mfma_f32_32x32x16_bf16 v[16:31], v[180:183], v[68:71], v[16:31]
    ds_read_b128 v[68:71], v3 offset:25600
    s_lshl_b32 s39, s49, 11
    s_add_u32 s39, s39, s44
    s_waitcnt lgkmcnt(7)
    v_mfma_f32_32x32x16_bf16 v[16:31], v[184:187], v[72:75], v[16:31]
    ds_read_b128 v[72:75], v3 offset:26624
    s_add_u32 s39, s39, 0x200000
    v_lshlrev_b32 v100, 10, v9
    s_waitcnt lgkmcnt(7)
    v_mfma_f32_32x32x16_bf16 v[16:31], v[188:191], v[76:79], v[16:31]
    ds_read_b128 v[76:79], v3 offset:27648
    v_lshl_add_u32 v103, v10, 4, v100
    v_lshl_add_u32 v100, v10, 5, v100
    s_waitcnt lgkmcnt(7)
    v_mfma_f32_32x32x16_bf16 v[16:31], v[192:195], v[80:83], v[16:31]
    ds_read_b128 v[80:83], v3 offset:28672
    s_lshl_b32 s40, s32, 15
    s_lshl_b32 s3, s33, 8
    s_waitcnt lgkmcnt(7)
    v_mfma_f32_32x32x16_bf16 v[16:31], v[196:199], v[84:87], v[16:31]
    ds_read_b128 v[84:87], v3 offset:29696
    s_add_u32 s40, s40, s3
    s_lshl_b32 s3, s49, 6
    s_waitcnt lgkmcnt(7)
    v_mfma_f32_32x32x16_bf16 v[16:31], v[200:203], v[88:91], v[16:31]
    ds_read_b128 v[88:91], v3 offset:30720
    s_add_u32 s40, s40, s3
    s_waitcnt lgkmcnt(7)
    v_mfma_f32_32x32x16_bf16 v[16:31], v[204:207], v[92:95], v[16:31]
    ds_read_b128 v[92:95], v3 offset:31744
    s_waitcnt lgkmcnt(7)
    v_mfma_f32_32x32x16_bf16 v[16:31], v[208:211], v[64:67], v[16:31]
    s_waitcnt lgkmcnt(6)
    v_mfma_f32_32x32x16_bf16 v[16:31], v[212:215], v[68:71], v[16:31]
    s_waitcnt lgkmcnt(5)
    v_mfma_f32_32x32x16_bf16 v[16:31], v[216:219], v[72:75], v[16:31]
    s_waitcnt lgkmcnt(4)
    v_mfma_f32_32x32x16_bf16 v[16:31], v[220:223], v[76:79], v[16:31]
    s_waitcnt lgkmcnt(3)
    v_mfma_f32_32x32x16_bf16 v[16:31], v[224:227], v[80:83], v[16:31]
    s_waitcnt lgkmcnt(2)
    v_mfma_f32_32x32x16_bf16 v[16:31], v[228:231], v[84:87], v[16:31]
    s_waitcnt lgkmcnt(1)
    v_mfma_f32_32x32x16_bf16 v[16:31], v[232:235], v[88:91], v[16:31]
    s_waitcnt lgkmcnt(0)
    v_mfma_f32_32x32x16_bf16 v[16:31], v[236:239], v[92:95], v[16:31]
    s_nop 11
    v_cvt_pk_bf16_f32 v32, v16, v17
    v_cvt_pk_bf16_f32 v33, v18, v19
    v_cvt_pk_bf16_f32 v34, v20, v21
    v_cvt_pk_bf16_f32 v35, v22, v23
    v_cvt_pk_bf16_f32 v36, v24, v25
    v_cvt_pk_bf16_f32 v37, v26, v27
    v_cvt_pk_bf16_f32 v38, v28, v29
    v_cvt_pk_bf16_f32 v39, v30, v31
    s_cmp_eq_u32 s50, 0
    s_cbranch_scc1 mg_l055
    buffer_store_dwordx4 v[32:35], v100, s[24:27], s40 offen
    buffer_store_dwordx4 v[36:39], v100, s[24:27], s40 offen offset:16
    s_branch mg_fin
mg_l055:
    ds_write_b128 v96, v[32:35]
    ds_write_b128 v96, v[36:39] offset:16
    ds_read_b64_tr_b16 v[44:45], v97 offset:0
    ds_read_b64_tr_b16 v[46:47], v97 offset:320
    ds_read_b64_tr_b16 v[48:49], v97 offset:32
    ds_read_b64_tr_b16 v[50:51], v97 offset:352
    v_pk_mul_f32 v[64:65], v[16:17], v[16:17]
    v_pk_add_f32 v[72:73], v[16:17], v[24:25]
    v_pk_mul_f32 v[66:67], v[18:19], v[18:19]
    v_pk_add_f32 v[74:75], v[18:19], v[26:27]
    v_pk_mul_f32 v[68:69], v[20:21], v[20:21]
    v_pk_add_f32 v[76:77], v[20:21], v[28:29]
    v_pk_mul_f32 v[70:71], v[22:23], v[22:23]
    v_pk_add_f32 v[78:79], v[22:23], v[30:31]
    v_pk_fma_f32 v[64:65], v[24:25], v[24:25], v[64:65]
    v_pk_fma_f32 v[66:67], v[26:27], v[26:27], v[66:67]
    v_pk_fma_f32 v[68:69], v[28:29], v[28:29], v[68:69]
    v_pk_fma_f32 v[70:71], v[30:31], v[30:31], v[70:71]
    v_pk_add_f32 v[72:73], v[72:73], v[74:75]
    v_pk_add_f32 v[76:77], v[76:77], v[78:79]
    v_pk_add_f32 v[64:65], v[64:65], v[66:67]
    v_pk_add_f32 v[68:69], v[68:69], v[70:71]
    v_pk_add_f32 v[72:73], v[72:73], v[76:77]
    v_pk_add_f32 v[64:65], v[64:65], v[68:69]
    v_add_f32 v40, v72, v73
    v_add_f32 v41, v64, v65
    s_nop 1
    v_permlane32_swap_b32 v40, v41
    v_add_f32 v40, v40, v41
    buffer_atomic_add_f32 v40, v98, s[28:31], s38 offen
    s_waitcnt lgkmcnt(2)
    buffer_store_dwordx4 v[44:47], v99, s[28:31], s39 offen sc1
    s_waitcnt lgkmcnt(0)
    buffer_store_dwordx4 v[48:51], v99, s[28:31], s39 offen offset:1024 sc1
    s_branch mg_p3e53
mg_p3e53f:
    v_mov_b32 v16, -1
    v_mov_b32 v17, -1
    v_mov_b32 v18, -1
    v_mov_b32 v19, -1
    v_lshrrev_b32 v20, 3, v0
    v_lshlrev_b32 v20, 15, v20
    v_and_b32 v21, 7, v0
    v_lshl_add_u32 v20, v21, 4, v20
    s_lshl_b32 s4, s57, 7
    s_add_u32 s4, s4, 6291456
    s_add_u32 s5, s4, 1048576
    buffer_store_dwordx4 v[16:19], v20, s[28:31], s4 offen sc1
    buffer_store_dwordx4 v[16:19], v20, s[28:31], s5 offen sc1
mg_p3e53:
    s_waitcnt vmcnt(0) lgkmcnt(0)
    s_barrier
    s_cmp_lg_u32 s47, 0
    s_cbranch_scc1 mg_na56
    s_bfe_u32 s4, s2, 0x30003
    s_lshl_b32 s4, s4, 8
    s_add_u32 s4, s4, s56
    v_mov_b32 v4, 1
    v_lshlrev_b32 v5, 11, v2
    s_mov_b64 exec, 0xff
    buffer_atomic_add v4, v5, s[28:31], s4 offen sc1
    s_mov_b64 exec, -1
mg_na56:
    v_lshlrev_b32 v8, 4, v0
    ds_write_b128 v8, v[244:247] offset:0
    ds_write_b128 v8, v[248:251] offset:8192
    ds_write_b128 v8, v[252:255] offset:16384
    v_mov_b32 v4, 0
    v_mov_b32 v5, 0
    v_mov_b32 v6, 0
    v_mov_b32 v7, 0
    v_and_b32 v8, 7, v0
    v_mul_u32_u24 v8, 1312, v8
    v_lshrrev_b32 v9, 3, v0
    v_lshl_add_u32 v8, v9, 4, v8
    v_cmp_gt_u32 vcc, 144, v0
    s_and_saveexec_b64 s[6:7], vcc
    ds_write_b128 v8, v[4:7] offset:24576
    s_mov_b64 exec, s[6:7]
    s_cmp_lg_u32 s47, 7
    s_cbranch_scc1 mg_zw57
    s_mov_b64 exec, 0xf
    ds_write_b128 v3, v[4:7] offset:35200
    ds_write_b128 v3, v[4:7] offset:38400
    ds_write_b128 v3, v[4:7] offset:41600
    ds_write_b128 v3, v[4:7] offset:43776
    ds_write_b128 v3, v[4:7] offset:45952
    ds_write_b128 v3, v[4:7] offset:48128
    ds_write_b128 v3, v[4:7] offset:51328
    ds_write_b128 v3, v[4:7] offset:54528
    ds_write_b128 v3, v[4:7] offset:56704
    ds_write_b128 v3, v[4:7] offset:58880
    s_mov_b64 exec, -1
mg_zw57:
    s_mov_b32 s50, 1
    s_mov_b32 s52, 4194304
    s_mov_b32 s53, 18874368
    s_mov_b32 s54, 22185984
    s_mov_b32 s63, 21037056
    s_mov_b32 s55, 8388608
    s_mov_b32 s62, 19021824
    s_cmp_lg_u32 s47, 0
    s_cbranch_scc1 mg_np58
    s_and_b32 s4, s2, 7
    s_lshl_b32 s4, s4, 11
    s_add_u32 s4, s4, s56
    v_lshlrev_b32 v5, 8, v2
    s_mov_b64 exec, 0xff
    s_mov_b32 s5, 0x40000
mg_pl59:
    s_sleep 4
    buffer_load_dword v4, v5, s[28:31], s4 offen sc1
    s_sub_u32 s5, s5, 1
    s_cbranch_scc1 mg_po60
    s_waitcnt vmcnt(0)
    v_cmp_ne_u32 vcc, 32, v4
    s_cbranch_vccnz mg_pl59
mg_po60:
    s_mov_b64 exec, -1
mg_np58:
    s_add_u32 s56, s56, 16384
    s_waitcnt lgkmcnt(0)
    s_barrier
    v_lshlrev_b32 v8, 4, v0
    v_lshrrev_b32 v9, 3, v0
    v_lshlrev_b32 v10, 15, v9
    v_and_b32 v11, 7, v0
    v_lshl_add_u32 v10, v11, 3, v10
    s_lshl_b32 s37, s57, 7
    s_add_u32 s40, s37, s52
    s_add_u32 s41, s40, 0x200000
    buffer_load_dwordx2 v[24:25], v10, s[28:31], s40 offen sc1
    buffer_load_dwordx2 v[26:27], v10, s[28:31], s40 offen offset:64 sc1
    s_mov_b32 s42, 18874368
    s_mov_b32 s43, 18882560
    buffer_load_dwordx4 v[16:19], v8, s[28:31], s42 offen sc1
    buffer_load_dwordx4 v[20:23], v8, s[28:31], s43 offen sc1
    s_branch mg_layer
mg_fin:
mg_end:
    s_endpgm
.section .rodata,"a"
.p2align 6
.amdhsa_kernel interleave_layers__ssm_conv_s4d__linear_kernel_hedgehog__prompt_kernel
  .amdhsa_next_free_vgpr 256
  .amdhsa_next_free_sgpr 95
  .amdhsa_accum_offset 256
  .amdhsa_group_segment_fixed_size 0
  .amdhsa_kernarg_size 112
  .amdhsa_user_sgpr_count 2
  .amdhsa_user_sgpr_kernarg_segment_ptr 1
  .amdhsa_system_sgpr_workgroup_id_x 1
  .amdhsa_float_denorm_mode_32 3
  .amdhsa_float_denorm_mode_16_64 3
.end_amdhsa_kernel
```
